```python
import torch

def _softmax(x, axis=-1):
    return torch.softmax(x, dim=axis)
def _gelu(x):
    return torch.nn.functional.gelu(x, approximate="tanh")
def _silu(x):
    return torch.nn.functional.silu(x)
def _sigmoid(x):
    return torch.sigmoid(x)
def _layernorm(x, axis=-1, eps=1e-5):
    m = x.mean(dim=axis, keepdim=True)
    v = x.var(dim=axis, keepdim=True, unbiased=False)
    return (x - m) / torch.sqrt(v + eps)
def _scatter_add(tgt, idx, src, axis=0):
    return tgt.clone().index_add_(axis, idx, src)
def _segment_sum(src, seg, n):
    out = torch.zeros((n,) + src.shape[1:], dtype=src.dtype)
    return out.index_add_(0, seg, src)
def _pad(x, pw):
    flat = tuple(v for pair in reversed(pw) for v in pair)
    return torch.nn.functional.pad(x, flat)

kernel_name = 'parallel_sum__sliding_block__dense_activation_squared_relu__prompt'

def setup_inputs():

    _w = (lambda a: (lambda t: t.to(torch.bfloat16) if t.is_floating_point() else t)(torch.as_tensor(a)))
    def _A_setup():
        B, S, D = 1, 2048, 512
        return {
            "x": _w((lambda *s: torch.randn(*s, dtype=torch.bfloat16) * 0.05)(B, S, D)),
            "wqkv": _w((lambda *s: torch.randn(*s, dtype=torch.bfloat16) * 0.1)(D, 3 * D)),
            "wo": _w((lambda *s: torch.randn(*s, dtype=torch.bfloat16) * 0.05)(D, D)),
        }
    _A_in = _A_setup()

    def _B_setup():
        B, S, D, F = 1, 2048, 512, 1792
        return {
            "x": _w((lambda *s: torch.randn(*s, dtype=torch.bfloat16) * 0.05)(B, S, D)),
            "w1": _w((lambda *s: torch.randn(*s, dtype=torch.bfloat16) * 0.05)(D, F)),
            "b1": _w((lambda *s: torch.randn(*s, dtype=torch.bfloat16) * 0.4)(F)),
            "w2": _w((lambda *s: torch.randn(*s, dtype=torch.bfloat16) * 0.05)(F, D)),
            "b2": _w((lambda *s: torch.randn(*s, dtype=torch.bfloat16) * 1.6)(D)),
        }
    _B_in = _B_setup()

    return {
        "A_x": _A_in["x"],
        "A_wqkv": _A_in["wqkv"],
        "A_wo": _A_in["wo"],
        "B_x": _B_in["x"],
        "B_w1": _B_in["w1"],
        "B_b1": _B_in["b1"],
        "B_w2": _B_in["w2"],
        "B_b2": _B_in["b2"],
    }

def reference(A_x, A_wqkv, A_wo, B_x, B_w1, B_b1, B_w2, B_b2):
    def _A_ref(x, wqkv, wo):
        B, S, D = x.shape
        H = 32; Dh = D // H; W = 256
        qkv = (lambda x, *d: x.permute(*d))((x @ wqkv).reshape(B, S, 3, H, Dh), 2, 0, 3, 1, 4)
        q, k, v = qkv[0], qkv[1], qkv[2]
        scores = torch.einsum("bhqd,bhkd->bhqk", q, k) * (Dh ** -0.5)
        idx = torch.arange(S)
        mask = (idx[:, None] - idx[None, :] >= 0) & (idx[:, None] - idx[None, :] < W)
        scores = torch.where(mask[None, None], scores, -1e9)
        p = _softmax(scores, axis=-1)
        o = torch.einsum("bhqk,bhkd->bhqd", p, v)
        return (lambda x, *d: x.permute(*d))(o, 0, 2, 1, 3).reshape(B, S, D) @ wo

    def _B_ref(x, w1, b1, w2, b2):
        h = torch.einsum("bsd,df->bsf", x, w1) + b1
        zero = torch.zeros_like(h)
        r = torch.where(h > zero, h, zero)
        h = r * r
        out = torch.einsum("bsf,fd->bsd", h, w2) + b2
        return out

    x = A_x
    xn = _layernorm(x, axis=-1)
    return x + _A_ref(xn, A_wqkv, A_wo) + _B_ref(xn, B_w1, B_b1, B_w2, B_b2)
```

```asm
; @launch grid=(256,1,1) block=(256,1,1) lds=163840
.amdgcn_target "amdgcn-amd-amdhsa--gfx950"
.text
.globl parallel_sum__sliding_block__dense_activation_squared_relu__prompt_kernel
.p2align 8
.type parallel_sum__sliding_block__dense_activation_squared_relu__prompt_kernel,@function
parallel_sum__sliding_block__dense_activation_squared_relu__prompt_kernel:
    s_load_dwordx2 s[4:5], s[0:1], 0
    s_load_dwordx2 s[8:9], s[0:1], 8
    v_lshrrev_b32 v1, 6, v0
    v_and_b32 v0, 63, v0
    s_cmp_ge_u32 s2, 256
    v_readfirstlane_b32 s38, v1
    s_cbranch_scc1 Lend
    s_and_b32 s40, s2, 1
    s_lshl_b32 s40, s40, 3
    s_bfe_u32 s41, s2, 0x30003
    s_add_u32 s40, s40, s41
    s_lshr_b32 s42, s2, 6
    s_bfe_u32 s53, s2, 0x20001
    s_lshl1_add_u32 s53, s2, s53
    s_add_u32 s43, s41, s42
    s_and_b32 s43, s43, 1
    s_xor_b32 s53, s53, s43
    s_lshl2_add_u32 s40, s40, s38
    s_and_b32 s53, s53, 3
    s_lshl_b32 s49, s40, 15
    v_lshrrev_b32 v36, 3, v0
    v_lshrrev_b32 v37, 4, v0
    v_xor_b32 v37, v37, v0
    v_and_b32 v37, 7, v37
    v_lshlrev_b32 v37, 4, v37
    v_lshl_add_u32 v48, v36, 10, v37
    s_mov_b32 s6, 2097152
    s_mov_b32 s7, 0x20000
    s_mul_i32 s39, s38, 40960
    s_lshl_b32 s3, s53, 8
    s_add_u32 s3, s3, s49
    s_mov_b32 m0, s39
    s_waitcnt lgkmcnt(0)
    buffer_load_dwordx4 v48, s[4:7], s3 offen offset:0 lds
    v_xor_b32 v36, 64, v48
    v_add_u32 v49, 7168, v36
    v_add_u32 v50, 14336, v48
    v_add_u32 v51, 21504, v36
    s_bfe_u32 s41, s2, 0x20001
    s_mov_b32 s10, 1572864
    s_mov_b32 s11, 0x20000
    buffer_load_dwordx4 v49, s[4:7], s3 offen offset:1024 lds
    s_lshl_b32 s43, s41, 1
    s_lshr_b32 s45, s42, 1
    s_add_u32 s43, s43, s45
    s_and_b32 s56, s42, 1
    buffer_load_dwordx4 v50, s[4:7], s3 offen offset:2048 lds
    s_lshl_b32 s45, s56, 10
    s_lshl_b32 s46, s43, 7
    s_add_u32 s45, s45, s46
    s_mul_i32 s47, s38, 98304
    buffer_load_dwordx4 v51, s[4:7], s3 offen offset:3072 lds
    s_add_u32 s45, s45, s47
    v_lshrrev_b32 v36, 3, v0
    v_mul_u32_u24 v36, 3072, v36
    s_add_u32 m0, s39, 4096
    s_add_u32 s3, s3, 128
    buffer_load_dwordx4 v48, s[4:7], s3 offen offset:0 lds
    v_lshrrev_b32 v37, 2, v0
    v_and_b32 v37, 4, v37
    v_xor_b32 v37, v37, v0
    v_and_b32 v37, 7, v37
    buffer_load_dwordx4 v49, s[4:7], s3 offen offset:1024 lds
    v_lshl_add_u32 v2, v37, 4, v36
    v_add_u32 v3, 23552, v2
    v_add_u32 v4, 47104, v2
    v_add_u32 v5, 70656, v2
    buffer_load_dwordx4 v50, s[4:7], s3 offen offset:2048 lds
    buffer_load_dwordx4 v51, s[4:7], s3 offen offset:3072 lds
    s_add_u32 m0, s39, 16384
    s_mul_i32 s3, s53, 393216
    s_add_u32 s3, s3, s45
    buffer_load_dwordx4 v2, s[8:11], s3 offen offset:0 lds
    s_load_dwordx16 s[68:83], s[0:1], 16
    s_load_dwordx2 s[24:25], s[0:1], 80
    s_getpc_b64 s[50:51]
Lpc:
    s_lshr_b32 s52, s2, 3
    buffer_load_dwordx4 v3, s[8:11], s3 offen offset:1024 lds
    s_lshl2_add_u32 s52, s52, s38
    s_lshl_b32 s52, s52, 8
    v_min_u32 v25, 1, v0
    v_lshl_add_u32 v25, v25, 7, s52
    v_min_u32 v25, Lhot-Lpc, v25
    buffer_load_dwordx4 v4, s[8:11], s3 offen offset:2048 lds
    global_load_dword a52, v25, s[50:51]
    s_lshl_b32 s48, s56, 6
    s_xor_b32 s46, s46, 0
    s_add_u32 s46, s46, s48
    s_add_u32 s46, s46, 2048
    buffer_load_dwordx4 v5, s[8:11], s3 offen offset:3072 lds
    s_add_u32 s46, s46, s47
    v_lshrrev_b32 v36, 2, v0
    v_mul_u32_u24 v36, 3072, v36
    v_and_b32 v37, 3, v0
    v_lshl_add_u32 v6, v37, 4, v36
    v_add_u32 v7, 48128, v6
    v_lshrrev_b32 v38, 5, v0
    v_bfe_u32 v37, v0, 2, 2
    v_lshl_add_u32 v36, v38, 3, v37
    v_and_b32 v37, 16, v0
    v_and_b32 v39, 3, v0
    v_lshl_add_u32 v37, v39, 2, v37
    v_lshlrev_b32 v37, 1, v37
    v_lshl_add_u32 v45, v36, 6, v37
    v_add_u32 v40, s39, v45
    v_lshl_add_u32 v36, v36, 7, v37
    v_and_b32 v37, 8, v0
    v_lshl_add_u32 v36, v37, 3, v36
    v_add_u32 v14, s39, v36
    v_xor_b32 v15, 64, v14
    s_xor_b32 s54, s38, 1
    s_mul_i32 s54, s54, 40960
    v_add_u32 v16, s54, v36
    v_add_u32 v41, s54, v45
    v_xor_b32 v17, 64, v16
    s_xor_b32 s54, s38, 2
    s_mul_i32 s54, s54, 40960
    v_add_u32 v18, s54, v36
    v_add_u32 v42, s54, v45
    v_xor_b32 v19, 64, v18
    s_xor_b32 s54, s38, 3
    s_mul_i32 s54, s54, 40960
    v_add_u32 v20, s54, v36
    v_add_u32 v43, s54, v45
    v_xor_b32 v21, 64, v20
    v_lshlrev_b32 v39, 9, v38
    v_sub_u32 v22, v14, v39
    v_xor_b32 v23, 64, v22
    v_and_b32 v36, 31, v0
    v_bfe_u32 v37, v0, 1, 3
    v_xor_b32 v37, v37, v38
    v_lshlrev_b32 v37, 4, v37
    v_lshl_add_u32 v36, v36, 7, v37
    s_and_b32 s54, s38, 1
    s_lshl_b32 s54, s54, 6
    s_lshr_b32 s55, s38, 1
    s_lshl_b32 s55, s55, 12
    s_add_u32 s55, s55, s39
    v_xor_b32 v36, s54, v36
    v_add_u32 v52, s55, v36
    v_xor_b32 v53, 32, v52
    v_xor_b32 v54, 64, v52
    v_xor_b32 v55, 96, v52
    v_xor_b32 v56, 4096, v52
    v_xor_b32 v57, 4128, v52
    v_xor_b32 v58, 4160, v52
    v_xor_b32 v59, 4192, v52
    v_bfe_u32 v37, v0, 4, 1
    v_lshlrev_b32 v37, 2, v37
    v_and_b32 v36, 15, v0
    v_sub_u32 v36, v36, v37
    v_mov_b32 v44, 0x3f803f80
    v_cmp_eq_u32 vcc, 0, v36
    s_nop 1
    v_cndmask_b32 v37, 0, v44, vcc
    v_cmp_eq_u32 vcc, 8, v36
    s_nop 1
    v_cndmask_b32 v39, 0, v44, vcc
    v_or_b32 v36, v37, v39
    v_accvgpr_write_b32 a32, v37
    v_accvgpr_write_b32 a36, v39
    v_accvgpr_write_b32 a60, v36
    v_accvgpr_write_b32 a33, v37
    v_accvgpr_write_b32 a37, v39
    v_accvgpr_write_b32 a61, v36
    v_accvgpr_write_b32 a34, v37
    v_accvgpr_write_b32 a38, v39
    v_accvgpr_write_b32 a62, v36
    v_accvgpr_write_b32 a35, v37
    v_accvgpr_write_b32 a39, v39
    v_accvgpr_write_b32 a63, v36
    v_lshlrev_b32 v1, 4, v0
    s_waitcnt lgkmcnt(0)
    s_mov_b32 s0, s53
    s_xor_b32 s1, s53, 1
    s_and_b32 s1, s1, 3
    s_xor_b32 s53, s53, 2
    s_mov_b64 s[20:21], s[68:69]
    s_mov_b64 s[12:13], s[72:73]
    s_mov_b64 s[32:33], s[74:75]
    s_mov_b64 s[16:17], s[76:77]
    s_mov_b64 s[34:35], s[78:79]
    s_mov_b64 s[28:29], s[80:81]
    s_mov_b64 s[36:37], s[82:83]
    s_mov_b32 s14, 1835008
    s_mov_b32 s15, 0x20000
    s_mov_b64 s[18:19], s[14:15]
    s_mov_b32 s22, 524288
    s_mov_b32 s23, 0x20000
    s_mov_b32 s26, 0x10000000
    s_mov_b32 s27, 0x20000
    s_lshl_b32 s50, s43, 8
    s_add_u32 s50, s50, s40
    s_lshl_b32 s50, s50, 10
    s_xor_b32 s43, s1, 2
    s_lshl_b32 s52, s56, 17
    s_xor_b32 s51, s50, 0
    s_add_u32 s51, s52, s51
    s_lshl4_add_u32 s50, s52, s50
    s_lshr_b32 s63, s40, 2
    s_lshl2_add_u32 s63, s63, s41
    s_lshl2_add_u32 s63, s63, s42
    s_lshl_b32 s63, s63, 7
    s_lshl2_add_u32 s63, s38, s63
    s_add_u32 s64, s63, 32768
    s_cmp_eq_u32 s56, 0
    s_cselect_b32 s56, 0x3eb8aa3b, 1.0
    s_lshl_b32 s47, s42, 1
    s_add_u32 s48, s47, 1
    s_add_u32 s52, s42, 2
    s_cmp_lt_u32 s42, 2
    s_cselect_b32 s47, s47, s52
    s_cselect_b32 s48, s48, 6
    s_mul_i32 s41, s41, 7
    s_add_u32 s47, s47, s41
    s_add_u32 s48, s48, s41
    s_mul_i32 s40, s40, 147456
    s_add_u32 s40, s40, 6488064
    s_lshl_b32 s52, s47, 12
    s_add_u32 s52, s52, s40
    s_lshl_b32 s54, s48, 12
    s_add_u32 s54, s54, s40
    s_add_u32 s55, s54, 2048
    s_cmp_eq_u32 s42, 3
    s_cselect_b32 s54, 0x80000000, s54
    s_add_u32 m0, s39, 32768
    s_mul_i32 s3, s0, 393216
    s_add_u32 s3, s3, s46
    buffer_load_dwordx4 v6, s[8:11], s3 offen offset:0 lds
    s_cmp_eq_u32 s42, 2
    s_cselect_b32 s55, 0x80000000, s55
    s_lshl_b32 s47, s47, 7
    s_lshl_b32 s48, s48, 7
    v_lshlrev_b32 v36, 1, v0
    v_add_u32 v33, s48, v36
    v_add_u32 v32, s47, v36
    s_mul_i32 s41, s38, 114688
    buffer_load_dwordx4 v7, s[8:11], s3 offen offset:1024 lds
    s_add_u32 s47, s47, s41
    s_add_u32 s48, s48, s41
    s_mov_b32 s44, 0xffff0000
    s_mov_b32 s67, 0x07060302
    s_mov_b64 s[30:31], s[6:7]
    v_lshrrev_b32 v38, 5, v0
    v_lshlrev_b32 v36, 3, v0
    v_add_u32 v31, s39, v36
    v_and_b32 v36, 0xf8, v36
    s_add_u32 m0, s39, 8192
    s_mul_i32 s3, s1, 256
    s_add_u32 s3, s3, s49
    buffer_load_dwordx4 v48, s[4:7], s3 offen offset:0 lds
    v_mul_u32_u24 v39, 81920, v38
    v_add_u32 v30, v36, v39
    v_and_b32 v36, 0xf0, v1
    v_lshl_add_u32 v36, v38, 9, v36
    v_and_b32 v37, 16, v0
    v_lshl_add_u32 v36, v37, 12, v36
    v_add_u32 v24, 4390912, v36
    s_and_b32 s40, s2, 1
    buffer_load_dwordx4 v49, s[4:7], s3 offen offset:1024 lds
    s_bfe_u32 s41, s2, 0x10001
    s_lshl1_add_u32 s40, s40, s41
    s_bfe_u32 s41, s2, 0x30003
    s_lshl3_add_u32 s40, s40, s41
    s_and_b32 s41, s2, 4
    s_lshr_b32 s57, s2, 6
    s_bfe_u32 s58, s2, 0x10001
    s_xor_b32 s58, s58, 3
    s_and_b32 s58, s58, 3
    buffer_load_dwordx4 v50, s[4:7], s3 offen offset:2048 lds
    s_xor_b32 s57, s57, s58
    s_add_u32 s41, s41, s57
    s_lshl_b32 s41, s41, 7
    s_mul_i32 s57, s38, 458752
    s_add_u32 s57, s57, s41
    s_lshl_b32 s58, s38, 17
    s_add_u32 s58, s58, s41
    s_lshl3_add_u32 s66, s40, s38
    s_lshl_b32 s66, s66, 13
    buffer_load_dwordx4 v51, s[4:7], s3 offen offset:3072 lds
    s_add_u32 s66, s66, s41
    s_mul_i32 s59, s40, 294912
    s_add_u32 s59, s59, 6488064
    v_lshrrev_b32 v36, 3, v0
    v_and_b32 v37, 0x70, v1
    v_lshl_add_u32 v34, v36, 10, v37
    v_add_u32 v35, 0x8000, v34
    v_add_u32 v8, 147456, v1
    s_add_u32 m0, s39, 12288
    s_mul_i32 s3, s1, 256
    s_add_u32 s3, s3, s49
    s_add_u32 s3, s3, 128
    buffer_load_dwordx4 v48, s[4:7], s3 offen offset:0 lds
    v_add_u32 v9, 2097152, v1
    s_and_b32 s40, s2, 7
    s_bfe_u32 s41, s2, 0x20003
    s_lshl2_add_u32 s40, s40, s41
    s_lshr_b32 s41, s2, 5
    s_lshl2_add_u32 s62, s41, s38
    s_lshl_b32 s60, s40, 16
    s_mul_i32 s61, s62, 294912
    s_lshl_b32 s41, s40, 10
    buffer_load_dwordx4 v49, s[4:7], s3 offen offset:1024 lds
    s_add_u32 s61, s61, s41
    s_add_u32 s61, s61, 6602752
    s_lshl_b32 s65, s2, 5
    s_add_u32 s65, s65, s38
    s_lshl_b32 s65, s65, 2
    s_add_u32 s65, s65, 98304
    v_and_b32 v36, 31, v0
    v_lshrrev_b32 v37, 5, v0
    buffer_load_dwordx4 v50, s[4:7], s3 offen offset:2048 lds
    v_lshlrev_b32 v37, 2, v37
    v_sub_u32 v36, v36, v37
    v_cmp_le_i32 s[68:69], 0, v36
    v_cmp_le_i32 s[70:71], 1, v36
    v_cmp_le_i32 s[72:73], 2, v36
    v_cmp_le_i32 s[74:75], 3, v36
    v_cmp_le_i32 s[76:77], 8, v36
    v_cmp_le_i32 s[78:79], 9, v36
    v_cmp_le_i32 s[80:81], 10, v36
    buffer_load_dwordx4 v51, s[4:7], s3 offen offset:3072 lds
    v_cmp_le_i32 s[82:83], 11, v36
    v_cmp_le_i32 s[84:85], 16, v36
    v_cmp_le_i32 s[86:87], 17, v36
    v_cmp_le_i32 s[88:89], 18, v36
    v_cmp_le_i32 s[90:91], 19, v36
    v_cmp_le_i32 s[92:93], 24, v36
    v_cmp_le_i32 s[94:95], 25, v36
    v_cmp_le_i32 s[96:97], 26, v36
    v_cmp_le_i32 s[98:99], 27, v36
    global_load_short_d16_hi v46, v32, s[32:33]
    global_load_short_d16_hi v47, v33, s[32:33]
    buffer_load_dwordx4 a[52:55], v34, s[4:7], s66 offen
    buffer_load_dwordx4 a[56:59], v35, s[4:7], s66 offen
    s_lshr_b32 s41, s2, 4
    s_cmp_eq_u32 s41, 4
    s_cbranch_scc0 Linit_1
    v_mov_b64 v[64:65], 0
    v_mov_b64 v[66:67], 0
    v_lshlrev_b32 v68, 7, v0
    s_and_b32 s41, s2, 15
    s_lshl2_add_u32 s41, s41, s38
    s_mul_i32 s41, s41, 2560
    s_mov_b64 exec, 0xfffff
    buffer_store_dwordx4 v[64:67], v68, s[24:27], s41 offen sc1
    s_mov_b64 exec, -1
Linit_1:
    s_waitcnt vmcnt(19)
    ds_read_b128 v[128:131], v52 offset:0
    ds_read_b128 v[132:135], v53 offset:0
    ds_read_b128 v[136:139], v54 offset:0
    ds_read_b128 v[140:143], v55 offset:0
    ds_read_b128 v[144:147], v56 offset:0
    ds_read_b128 v[148:151], v57 offset:0
    ds_read_b128 v[152:155], v58 offset:0
    ds_read_b128 v[156:159], v59 offset:0
    s_waitcnt vmcnt(12)
    s_barrier
    ds_read_b64_tr_b16 a[0:1], v14 offset:16384
    ds_read_b64_tr_b16 a[2:3], v14 offset:16896
    ds_read_b64_tr_b16 a[4:5], v15 offset:16384
    ds_read_b64_tr_b16 a[6:7], v15 offset:16896
    ds_read_b64_tr_b16 a[8:9], v40 offset:32768
    ds_read_b64_tr_b16 a[10:11], v40 offset:33024
    ds_read_b64_tr_b16 a[12:13], v14 offset:18432
    ds_read_b64_tr_b16 a[14:15], v14 offset:18944
    ds_read_b64_tr_b16 a[16:17], v15 offset:18432
    ds_read_b64_tr_b16 a[18:19], v15 offset:18944
    ds_read_b64_tr_b16 a[20:21], v40 offset:33792
    ds_read_b64_tr_b16 a[22:23], v40 offset:34048
    ds_read_b64_tr_b16 a[24:25], v16 offset:16384
    ds_read_b64_tr_b16 a[26:27], v16 offset:16896
    s_waitcnt lgkmcnt(6)
    v_mfma_f32_32x32x16_bf16 v[64:79], a[0:3], v[128:131], 0
    ds_read_b64_tr_b16 a[28:29], v17 offset:16384
    ds_read_b64_tr_b16 a[30:31], v17 offset:16896
    s_add_u32 m0, s39, 20480
    s_mul_i32 s3, s1, 393216
    s_add_u32 s3, s3, s45
    buffer_load_dwordx4 v2, s[8:11], s3 offen offset:0 lds
    v_mfma_f32_16x16x32_bf16 v[32:35], a[32:35], a[0:3], 0
    v_mfma_f32_32x32x16_bf16 v[80:95], a[4:7], v[128:131], 0
    ds_read_b64_tr_b16 a[0:1], v41 offset:32768
    ds_read_b64_tr_b16 a[2:3], v41 offset:33024
    buffer_load_dwordx4 v3, s[8:11], s3 offen offset:1024 lds
    v_mfma_f32_16x16x32_bf16 v[32:35], a[36:39], a[4:7], v[32:35]
    v_mfma_f32_32x32x16_bf16 v[96:111], v[128:131], a[8:11], 0
    ds_read_b64_tr_b16 a[4:5], v16 offset:18432
    ds_read_b64_tr_b16 a[6:7], v16 offset:18944
    buffer_load_dwordx4 v4, s[8:11], s3 offen offset:2048 lds
    v_mfma_f32_16x16x32_bf16 v[10:13], a[32:35], a[8:11], 0
    v_mfma_f32_16x16x32_bf16 v[60:63], a[60:63], v[128:131], 0
    buffer_load_dwordx4 v5, s[8:11], s3 offen offset:3072 lds
    v_mfma_f32_32x32x16_bf16 v[64:79], a[12:15], v[132:135], v[64:79]
    ds_read_b64_tr_b16 a[8:9], v17 offset:18432
    ds_read_b64_tr_b16 a[10:11], v17 offset:18944
    s_add_u32 m0, s39, 34816
    s_mul_i32 s3, s1, 393216
    s_add_u32 s3, s3, s46
    v_mfma_f32_16x16x32_bf16 v[32:35], a[32:35], a[12:15], v[32:35]
    buffer_load_dwordx4 v6, s[8:11], s3 offen offset:0 lds
    s_waitcnt lgkmcnt(6)
    v_mfma_f32_32x32x16_bf16 v[80:95], a[16:19], v[132:135], v[80:95]
    ds_read_b64_tr_b16 a[12:13], v41 offset:33792
    ds_read_b64_tr_b16 a[14:15], v41 offset:34048
    v_mfma_f32_16x16x32_bf16 v[32:35], a[36:39], a[16:19], v[32:35]
    buffer_load_dwordx4 v7, s[8:11], s3 offen offset:1024 lds
    v_mfma_f32_32x32x16_bf16 v[96:111], v[132:135], a[20:23], v[96:111]
    ds_read_b64_tr_b16 a[16:17], v18 offset:16384
    ds_read_b64_tr_b16 a[18:19], v18 offset:16896
    s_add_u32 m0, s39, 0
    s_mul_i32 s3, s53, 256
    s_add_u32 s3, s3, s49
    v_mfma_f32_16x16x32_bf16 v[10:13], a[32:35], a[20:23], v[10:13]
    buffer_load_dwordx4 v48, s[4:7], s3 offen offset:0 lds
    v_mfma_f32_16x16x32_bf16 v[60:63], a[60:63], v[132:135], v[60:63]
    v_mfma_f32_32x32x16_bf16 v[64:79], a[24:27], v[136:139], v[64:79]
    ds_read_b64_tr_b16 a[20:21], v19 offset:16384
    ds_read_b64_tr_b16 a[22:23], v19 offset:16896
    buffer_load_dwordx4 v49, s[4:7], s3 offen offset:1024 lds
    v_mfma_f32_32x32x16_bf16 v[80:95], a[28:31], v[136:139], v[80:95]
    ds_read_b64_tr_b16 a[24:25], v42 offset:32768
    ds_read_b64_tr_b16 a[26:27], v42 offset:33024
    s_waitcnt lgkmcnt(6)
    v_mfma_f32_32x32x16_bf16 v[96:111], v[136:139], a[0:3], v[96:111]
    ds_read_b64_tr_b16 a[28:29], v18 offset:18432
    ds_read_b64_tr_b16 a[30:31], v18 offset:18944
    buffer_load_dwordx4 v50, s[4:7], s3 offen offset:2048 lds
    v_mfma_f32_16x16x32_bf16 v[60:63], a[60:63], v[136:139], v[60:63]
    v_mfma_f32_32x32x16_bf16 v[64:79], a[4:7], v[140:143], v[64:79]
    ds_read_b64_tr_b16 a[0:1], v19 offset:18432
    ds_read_b64_tr_b16 a[2:3], v19 offset:18944
    buffer_load_dwordx4 v51, s[4:7], s3 offen offset:3072 lds
    s_add_u32 m0, s39, 4096
    s_mul_i32 s3, s53, 256
    s_add_u32 s3, s3, s49
    s_add_u32 s3, s3, 128
    v_mfma_f32_32x32x16_bf16 v[80:95], a[8:11], v[140:143], v[80:95]
    ds_read_b64_tr_b16 a[4:5], v42 offset:33792
    ds_read_b64_tr_b16 a[6:7], v42 offset:34048
    s_waitcnt vmcnt(14)
    ds_read_b128 v[160:163], v52 offset:8192
    buffer_load_dwordx4 v48, s[4:7], s3 offen offset:0 lds
    v_mfma_f32_32x32x16_bf16 v[96:111], v[140:143], a[12:15], v[96:111]
    ds_read_b64_tr_b16 a[8:9], v20 offset:16384
    ds_read_b64_tr_b16 a[10:11], v20 offset:16896
    ds_read_b128 v[164:167], v53 offset:8192
    buffer_load_dwordx4 v49, s[4:7], s3 offen offset:1024 lds
    v_mfma_f32_16x16x32_bf16 v[60:63], a[60:63], v[140:143], v[60:63]
    ds_read_b128 v[168:171], v54 offset:8192
    v_mfma_f32_4x4x4_16b_bf16 v[112:115], v[128:129], v[128:129], 0
    v_mfma_f32_4x4x4_16b_bf16 v[116:119], v[130:131], v[130:131], 0
    v_mfma_f32_4x4x4_16b_bf16 v[120:123], v[132:133], v[132:133], 0
    buffer_load_dwordx4 v50, s[4:7], s3 offen offset:2048 lds
    v_mfma_f32_4x4x4_16b_bf16 v[124:127], v[134:135], v[134:135], 0
    v_mfma_f32_4x4x4_16b_bf16 v[112:115], v[136:137], v[136:137], v[112:115]
    v_mfma_f32_4x4x4_16b_bf16 v[116:119], v[138:139], v[138:139], v[116:119]
    v_mfma_f32_4x4x4_16b_bf16 v[120:123], v[140:141], v[140:141], v[120:123]
    v_mfma_f32_4x4x4_16b_bf16 v[124:127], v[142:143], v[142:143], v[124:127]
    s_waitcnt lgkmcnt(9)
    v_mfma_f32_32x32x16_bf16 v[64:79], a[16:19], v[144:147], v[64:79]
    ds_read_b64_tr_b16 a[12:13], v21 offset:16384
    ds_read_b64_tr_b16 a[14:15], v21 offset:16896
    ds_read_b128 v[172:175], v55 offset:8192
    buffer_load_dwordx4 v51, s[4:7], s3 offen offset:3072 lds
    s_add_u32 m0, s39, 24576
    s_mul_i32 s3, s53, 393216
    s_add_u32 s3, s3, s45
    v_mfma_f32_32x32x16_bf16 v[80:95], a[20:23], v[144:147], v[80:95]
    ds_read_b64_tr_b16 a[16:17], v43 offset:32768
    ds_read_b64_tr_b16 a[18:19], v43 offset:33024
    ds_read_b128 v[176:179], v56 offset:8192
    buffer_load_dwordx4 v2, s[8:11], s3 offen offset:0 lds
    v_mfma_f32_32x32x16_bf16 v[96:111], v[144:147], a[24:27], v[96:111]
    ds_read_b64_tr_b16 a[20:21], v20 offset:18432
    ds_read_b64_tr_b16 a[22:23], v20 offset:18944
    ds_read_b128 v[180:183], v57 offset:8192
    v_mfma_f32_16x16x32_bf16 v[60:63], a[60:63], v[144:147], v[60:63]
    ds_read_b128 v[184:187], v58 offset:8192
    buffer_load_dwordx4 v3, s[8:11], s3 offen offset:1024 lds
    v_mfma_f32_32x32x16_bf16 v[64:79], a[28:31], v[148:151], v[64:79]
    ds_read_b64_tr_b16 a[24:25], v21 offset:18432
    ds_read_b64_tr_b16 a[26:27], v21 offset:18944
    ds_read_b128 v[188:191], v59 offset:8192
    s_waitcnt lgkmcnt(11)
    v_mfma_f32_32x32x16_bf16 v[80:95], a[0:3], v[148:151], v[80:95]
    ds_read_b64_tr_b16 a[28:29], v43 offset:33792
    ds_read_b64_tr_b16 a[30:31], v43 offset:34048
    buffer_load_dwordx4 v4, s[8:11], s3 offen offset:2048 lds
    v_mfma_f32_32x32x16_bf16 v[96:111], v[148:151], a[4:7], v[96:111]
    s_waitcnt vmcnt(11)
    s_barrier
    ds_read_b64_tr_b16 a[0:1], v14 offset:20480
    ds_read_b64_tr_b16 a[2:3], v14 offset:20992
    v_mfma_f32_16x16x32_bf16 v[60:63], a[60:63], v[148:151], v[60:63]
    buffer_load_dwordx4 v5, s[8:11], s3 offen offset:3072 lds
    s_add_u32 m0, s39, 36864
    s_mul_i32 s3, s53, 393216
    v_mfma_f32_32x32x16_bf16 v[64:79], a[8:11], v[152:155], v[64:79]
    ds_read_b64_tr_b16 a[4:5], v15 offset:20480
    ds_read_b64_tr_b16 a[6:7], v15 offset:20992
    s_add_u32 s3, s3, s46
    buffer_load_dwordx4 v6, s[8:11], s3 offen offset:0 lds
    v_mfma_f32_32x32x16_bf16 v[80:95], a[12:15], v[152:155], v[80:95]
    ds_read_b64_tr_b16 a[8:9], v40 offset:34816
    ds_read_b64_tr_b16 a[10:11], v40 offset:35072
    s_waitcnt lgkmcnt(6)
    v_mfma_f32_32x32x16_bf16 v[96:111], v[152:155], a[16:19], v[96:111]
    ds_read_b64_tr_b16 a[12:13], v14 offset:22528
    ds_read_b64_tr_b16 a[14:15], v14 offset:23040
    buffer_load_dwordx4 v7, s[8:11], s3 offen offset:1024 lds
    v_mfma_f32_16x16x32_bf16 v[60:63], a[60:63], v[152:155], v[60:63]
    v_mfma_f32_32x32x16_bf16 v[64:79], a[20:23], v[156:159], v[64:79]
    ds_read_b64_tr_b16 a[16:17], v15 offset:22528
    ds_read_b64_tr_b16 a[18:19], v15 offset:23040
    v_mfma_f32_32x32x16_bf16 v[80:95], a[24:27], v[156:159], v[80:95]
    ds_read_b64_tr_b16 a[20:21], v40 offset:35840
    ds_read_b64_tr_b16 a[22:23], v40 offset:36096
    v_mfma_f32_32x32x16_bf16 v[96:111], v[156:159], a[28:31], v[96:111]
    ds_read_b64_tr_b16 a[24:25], v16 offset:20480
    ds_read_b64_tr_b16 a[26:27], v16 offset:20992
    v_mfma_f32_16x16x32_bf16 v[60:63], a[60:63], v[156:159], v[60:63]
    v_mfma_f32_4x4x4_16b_bf16 v[112:115], v[144:145], v[144:145], v[112:115]
    v_mfma_f32_4x4x4_16b_bf16 v[116:119], v[146:147], v[146:147], v[116:119]
    v_mfma_f32_4x4x4_16b_bf16 v[120:123], v[148:149], v[148:149], v[120:123]
    v_mfma_f32_4x4x4_16b_bf16 v[124:127], v[150:151], v[150:151], v[124:127]
    v_mfma_f32_4x4x4_16b_bf16 v[112:115], v[152:153], v[152:153], v[112:115]
    v_mfma_f32_4x4x4_16b_bf16 v[116:119], v[154:155], v[154:155], v[116:119]
    v_mfma_f32_4x4x4_16b_bf16 v[120:123], v[156:157], v[156:157], v[120:123]
    v_mfma_f32_4x4x4_16b_bf16 v[124:127], v[158:159], v[158:159], v[124:127]
    s_waitcnt lgkmcnt(6)
    v_mfma_f32_32x32x16_bf16 v[64:79], a[0:3], v[160:163], v[64:79]
    ds_read_b64_tr_b16 a[28:29], v17 offset:20480
    ds_read_b64_tr_b16 a[30:31], v17 offset:20992
    s_add_u32 m0, s39, 8192
    s_mul_i32 s3, s43, 256
    s_add_u32 s3, s3, s49
    buffer_load_dwordx4 v48, s[4:7], s3 offen offset:0 lds
    v_mfma_f32_16x16x32_bf16 v[32:35], a[32:35], a[0:3], v[32:35]
    v_mfma_f32_32x32x16_bf16 v[80:95], a[4:7], v[160:163], v[80:95]
    ds_read_b64_tr_b16 a[0:1], v41 offset:34816
    ds_read_b64_tr_b16 a[2:3], v41 offset:35072
    buffer_load_dwordx4 v49, s[4:7], s3 offen offset:1024 lds
    v_mfma_f32_16x16x32_bf16 v[32:35], a[36:39], a[4:7], v[32:35]
    v_mfma_f32_32x32x16_bf16 v[96:111], v[160:163], a[8:11], v[96:111]
    ds_read_b64_tr_b16 a[4:5], v16 offset:22528
    ds_read_b64_tr_b16 a[6:7], v16 offset:23040
    buffer_load_dwordx4 v50, s[4:7], s3 offen offset:2048 lds
    v_mfma_f32_16x16x32_bf16 v[10:13], a[32:35], a[8:11], v[10:13]
    v_mfma_f32_16x16x32_bf16 v[60:63], a[60:63], v[160:163], v[60:63]
    buffer_load_dwordx4 v51, s[4:7], s3 offen offset:3072 lds
    s_add_u32 m0, s39, 12288
    v_mfma_f32_32x32x16_bf16 v[64:79], a[12:15], v[164:167], v[64:79]
    ds_read_b64_tr_b16 a[8:9], v17 offset:22528
    ds_read_b64_tr_b16 a[10:11], v17 offset:23040
    s_mul_i32 s3, s43, 256
    s_add_u32 s3, s3, s49
    s_add_u32 s3, s3, 128
    v_mfma_f32_16x16x32_bf16 v[32:35], a[32:35], a[12:15], v[32:35]
    buffer_load_dwordx4 v48, s[4:7], s3 offen offset:0 lds
    s_waitcnt lgkmcnt(6)
    v_mfma_f32_32x32x16_bf16 v[80:95], a[16:19], v[164:167], v[80:95]
    ds_read_b64_tr_b16 a[12:13], v41 offset:35840
    ds_read_b64_tr_b16 a[14:15], v41 offset:36096
    v_mfma_f32_16x16x32_bf16 v[32:35], a[36:39], a[16:19], v[32:35]
    buffer_load_dwordx4 v49, s[4:7], s3 offen offset:1024 lds
    v_mfma_f32_32x32x16_bf16 v[96:111], v[164:167], a[20:23], v[96:111]
    ds_read_b64_tr_b16 a[16:17], v18 offset:20480
    ds_read_b64_tr_b16 a[18:19], v18 offset:20992
    v_mfma_f32_16x16x32_bf16 v[10:13], a[32:35], a[20:23], v[10:13]
    buffer_load_dwordx4 v50, s[4:7], s3 offen offset:2048 lds
    v_mfma_f32_16x16x32_bf16 v[60:63], a[60:63], v[164:167], v[60:63]
    v_mfma_f32_32x32x16_bf16 v[64:79], a[24:27], v[168:171], v[64:79]
    ds_read_b64_tr_b16 a[20:21], v19 offset:20480
    ds_read_b64_tr_b16 a[22:23], v19 offset:20992
    buffer_load_dwordx4 v51, s[4:7], s3 offen offset:3072 lds
    s_add_u32 m0, s39, 28672
    v_mfma_f32_32x32x16_bf16 v[80:95], a[28:31], v[168:171], v[80:95]
    ds_read_b64_tr_b16 a[24:25], v42 offset:34816
    ds_read_b64_tr_b16 a[26:27], v42 offset:35072
    s_mul_i32 s3, s43, 393216
    s_add_u32 s3, s3, s45
    s_waitcnt lgkmcnt(6)
    v_mfma_f32_32x32x16_bf16 v[96:111], v[168:171], a[0:3], v[96:111]
    ds_read_b64_tr_b16 a[28:29], v18 offset:22528
    ds_read_b64_tr_b16 a[30:31], v18 offset:23040
    buffer_load_dwordx4 v2, s[8:11], s3 offen offset:0 lds
    v_mfma_f32_16x16x32_bf16 v[60:63], a[60:63], v[168:171], v[60:63]
    v_mfma_f32_32x32x16_bf16 v[64:79], a[4:7], v[172:175], v[64:79]
    ds_read_b64_tr_b16 a[0:1], v19 offset:22528
    ds_read_b64_tr_b16 a[2:3], v19 offset:23040
    buffer_load_dwordx4 v3, s[8:11], s3 offen offset:1024 lds
    v_mfma_f32_32x32x16_bf16 v[80:95], a[8:11], v[172:175], v[80:95]
    ds_read_b64_tr_b16 a[4:5], v42 offset:35840
    ds_read_b64_tr_b16 a[6:7], v42 offset:36096
    s_waitcnt vmcnt(16)
    ds_read_b128 v[192:195], v52 offset:0
    buffer_load_dwordx4 v4, s[8:11], s3 offen offset:2048 lds
    v_mfma_f32_32x32x16_bf16 v[96:111], v[172:175], a[12:15], v[96:111]
    ds_read_b64_tr_b16 a[8:9], v20 offset:20480
    ds_read_b64_tr_b16 a[10:11], v20 offset:20992
    ds_read_b128 v[196:199], v53 offset:0
    buffer_load_dwordx4 v5, s[8:11], s3 offen offset:3072 lds
    v_mfma_f32_16x16x32_bf16 v[60:63], a[60:63], v[172:175], v[60:63]
    ds_read_b128 v[200:203], v54 offset:0
    s_add_u32 m0, s39, 38912
    v_mfma_f32_4x4x4_16b_bf16 v[112:115], v[160:161], v[160:161], v[112:115]
    s_mul_i32 s3, s43, 393216
    v_mfma_f32_4x4x4_16b_bf16 v[116:119], v[162:163], v[162:163], v[116:119]
    s_add_u32 s3, s3, s46
    v_mfma_f32_4x4x4_16b_bf16 v[120:123], v[164:165], v[164:165], v[120:123]
    buffer_load_dwordx4 v6, s[8:11], s3 offen offset:0 lds
    v_mfma_f32_4x4x4_16b_bf16 v[124:127], v[166:167], v[166:167], v[124:127]
    v_mfma_f32_4x4x4_16b_bf16 v[112:115], v[168:169], v[168:169], v[112:115]
    v_mfma_f32_4x4x4_16b_bf16 v[116:119], v[170:171], v[170:171], v[116:119]
    v_mfma_f32_4x4x4_16b_bf16 v[120:123], v[172:173], v[172:173], v[120:123]
    v_mfma_f32_4x4x4_16b_bf16 v[124:127], v[174:175], v[174:175], v[124:127]
    s_waitcnt lgkmcnt(9)
    v_mfma_f32_32x32x16_bf16 v[64:79], a[16:19], v[176:179], v[64:79]
    ds_read_b64_tr_b16 a[12:13], v21 offset:20480
    ds_read_b64_tr_b16 a[14:15], v21 offset:20992
    ds_read_b128 v[204:207], v55 offset:0
    buffer_load_dwordx4 v7, s[8:11], s3 offen offset:1024 lds
    v_lshrrev_b32 v36, 3, v0
    v_mul_u32_u24 v36, 3584, v36
    v_lshrrev_b32 v37, 2, v0
    v_and_b32 v37, 4, v37
    v_xor_b32 v37, v37, v0
    v_and_b32 v37, 7, v37
    v_lshl_add_u32 v2, v37, 4, v36
    v_add_u32 v3, 27648, v2
    v_add_u32 v4, 55296, v2
    v_add_u32 v5, 82944, v2
    v_mfma_f32_32x32x16_bf16 v[80:95], a[20:23], v[176:179], v[80:95]
    ds_read_b64_tr_b16 a[16:17], v43 offset:34816
    ds_read_b64_tr_b16 a[18:19], v43 offset:35072
    ds_read_b128 v[208:211], v56 offset:0
    s_lshl2_add_u32 s41, s2, s38
    v_lshlrev_b32 v38, 7, v0
    s_mul_i32 s40, s41, 1792
    s_mov_b64 exec, 0x3fff
    buffer_load_dword a192, v38, s[16:19], s40 offen
    s_lshl_b32 s40, s41, 9
    s_mov_b64 exec, 15
    buffer_load_dword a192, v38, s[20:23], s40 offen
    s_mov_b64 exec, -1
    v_mfma_f32_32x32x16_bf16 v[96:111], v[176:179], a[24:27], v[96:111]
    ds_read_b64_tr_b16 a[20:21], v20 offset:22528
    ds_read_b64_tr_b16 a[22:23], v20 offset:23040
    ds_read_b128 v[212:215], v57 offset:0
    v_mfma_f32_16x16x32_bf16 v[60:63], a[60:63], v[176:179], v[60:63]
    ds_read_b128 v[216:219], v58 offset:0
    v_mfma_f32_32x32x16_bf16 v[64:79], a[28:31], v[180:183], v[64:79]
    ds_read_b64_tr_b16 a[24:25], v21 offset:22528
    ds_read_b64_tr_b16 a[26:27], v21 offset:23040
    ds_read_b128 v[220:223], v59 offset:0
    s_waitcnt lgkmcnt(11)
    v_mfma_f32_32x32x16_bf16 v[80:95], a[0:3], v[180:183], v[80:95]
    ds_read_b64_tr_b16 a[28:29], v43 offset:35840
    ds_read_b64_tr_b16 a[30:31], v43 offset:36096
    v_mfma_f32_32x32x16_bf16 v[96:111], v[180:183], a[4:7], v[96:111]
    s_waitcnt vmcnt(16)
    s_barrier
    ds_read_b64_tr_b16 a[0:1], v14 offset:24576
    ds_read_b64_tr_b16 a[2:3], v14 offset:25088
    v_mfma_f32_16x16x32_bf16 v[60:63], a[60:63], v[180:183], v[60:63]
    v_mfma_f32_32x32x16_bf16 v[64:79], a[8:11], v[184:187], v[64:79]
    ds_read_b64_tr_b16 a[4:5], v15 offset:24576
    ds_read_b64_tr_b16 a[6:7], v15 offset:25088
    v_mfma_f32_32x32x16_bf16 v[80:95], a[12:15], v[184:187], v[80:95]
    ds_read_b64_tr_b16 a[8:9], v40 offset:36864
    ds_read_b64_tr_b16 a[10:11], v40 offset:37120
    s_waitcnt lgkmcnt(6)
    v_mfma_f32_32x32x16_bf16 v[96:111], v[184:187], a[16:19], v[96:111]
    ds_read_b64_tr_b16 a[12:13], v14 offset:26624
    ds_read_b64_tr_b16 a[14:15], v14 offset:27136
    v_mfma_f32_16x16x32_bf16 v[60:63], a[60:63], v[184:187], v[60:63]
    v_mfma_f32_32x32x16_bf16 v[64:79], a[20:23], v[188:191], v[64:79]
    ds_read_b64_tr_b16 a[16:17], v15 offset:26624
    ds_read_b64_tr_b16 a[18:19], v15 offset:27136
    v_mfma_f32_32x32x16_bf16 v[80:95], a[24:27], v[188:191], v[80:95]
    ds_read_b64_tr_b16 a[20:21], v40 offset:37888
    ds_read_b64_tr_b16 a[22:23], v40 offset:38144
    v_mfma_f32_32x32x16_bf16 v[96:111], v[188:191], a[28:31], v[96:111]
    ds_read_b64_tr_b16 a[24:25], v16 offset:24576
    ds_read_b64_tr_b16 a[26:27], v16 offset:25088
    v_mfma_f32_16x16x32_bf16 v[60:63], a[60:63], v[188:191], v[60:63]
    v_mfma_f32_4x4x4_16b_bf16 v[112:115], v[176:177], v[176:177], v[112:115]
    v_mfma_f32_4x4x4_16b_bf16 v[116:119], v[178:179], v[178:179], v[116:119]
    v_mfma_f32_4x4x4_16b_bf16 v[120:123], v[180:181], v[180:181], v[120:123]
    v_mfma_f32_4x4x4_16b_bf16 v[124:127], v[182:183], v[182:183], v[124:127]
    v_mfma_f32_4x4x4_16b_bf16 v[112:115], v[184:185], v[184:185], v[112:115]
    v_mfma_f32_4x4x4_16b_bf16 v[116:119], v[186:187], v[186:187], v[116:119]
    v_mfma_f32_4x4x4_16b_bf16 v[120:123], v[188:189], v[188:189], v[120:123]
    v_mfma_f32_4x4x4_16b_bf16 v[124:127], v[190:191], v[190:191], v[124:127]
    s_waitcnt lgkmcnt(6)
    v_mfma_f32_32x32x16_bf16 v[64:79], a[0:3], v[192:195], v[64:79]
    ds_read_b64_tr_b16 a[28:29], v17 offset:24576
    ds_read_b64_tr_b16 a[30:31], v17 offset:25088
    s_add_u32 m0, s39, 0
    s_mul_i32 s3, s0, 458752
    s_add_u32 s3, s3, s47
    buffer_load_dwordx4 v2, s[12:15], s3 offen offset:0 lds
    v_mfma_f32_16x16x32_bf16 v[32:35], a[32:35], a[0:3], v[32:35]
    v_mfma_f32_32x32x16_bf16 v[80:95], a[4:7], v[192:195], v[80:95]
    ds_read_b64_tr_b16 a[0:1], v41 offset:36864
    ds_read_b64_tr_b16 a[2:3], v41 offset:37120
    buffer_load_dwordx4 v3, s[12:15], s3 offen offset:1024 lds
    v_mfma_f32_16x16x32_bf16 v[32:35], a[36:39], a[4:7], v[32:35]
    v_mfma_f32_32x32x16_bf16 v[96:111], v[192:195], a[8:11], v[96:111]
    ds_read_b64_tr_b16 a[4:5], v16 offset:26624
    ds_read_b64_tr_b16 a[6:7], v16 offset:27136
    buffer_load_dwordx4 v4, s[12:15], s3 offen offset:2048 lds
    v_mfma_f32_16x16x32_bf16 v[10:13], a[32:35], a[8:11], v[10:13]
    v_mfma_f32_16x16x32_bf16 v[60:63], a[60:63], v[192:195], v[60:63]
    buffer_load_dwordx4 v5, s[12:15], s3 offen offset:3072 lds
    v_mfma_f32_32x32x16_bf16 v[64:79], a[12:15], v[196:199], v[64:79]
    ds_read_b64_tr_b16 a[8:9], v17 offset:26624
    ds_read_b64_tr_b16 a[10:11], v17 offset:27136
    s_add_u32 m0, s39, 4096
    s_mul_i32 s3, s1, 458752
    s_add_u32 s3, s3, s47
    v_mfma_f32_16x16x32_bf16 v[32:35], a[32:35], a[12:15], v[32:35]
    buffer_load_dwordx4 v2, s[12:15], s3 offen offset:0 lds
    s_waitcnt lgkmcnt(6)
    v_mfma_f32_32x32x16_bf16 v[80:95], a[16:19], v[196:199], v[80:95]
    ds_read_b64_tr_b16 a[12:13], v41 offset:37888
    ds_read_b64_tr_b16 a[14:15], v41 offset:38144
    v_mfma_f32_16x16x32_bf16 v[32:35], a[36:39], a[16:19], v[32:35]
    buffer_load_dwordx4 v3, s[12:15], s3 offen offset:1024 lds
    v_mfma_f32_32x32x16_bf16 v[96:111], v[196:199], a[20:23], v[96:111]
    ds_read_b64_tr_b16 a[16:17], v18 offset:24576
    ds_read_b64_tr_b16 a[18:19], v18 offset:25088
    v_mfma_f32_16x16x32_bf16 v[10:13], a[32:35], a[20:23], v[10:13]
    buffer_load_dwordx4 v4, s[12:15], s3 offen offset:2048 lds
    v_mfma_f32_16x16x32_bf16 v[60:63], a[60:63], v[196:199], v[60:63]
    v_mfma_f32_32x32x16_bf16 v[64:79], a[24:27], v[200:203], v[64:79]
    ds_read_b64_tr_b16 a[20:21], v19 offset:24576
    ds_read_b64_tr_b16 a[22:23], v19 offset:25088
    buffer_load_dwordx4 v5, s[12:15], s3 offen offset:3072 lds
    v_mfma_f32_32x32x16_bf16 v[80:95], a[28:31], v[200:203], v[80:95]
    ds_read_b64_tr_b16 a[24:25], v42 offset:36864
    ds_read_b64_tr_b16 a[26:27], v42 offset:37120
    s_waitcnt lgkmcnt(6)
    v_mfma_f32_32x32x16_bf16 v[96:111], v[200:203], a[0:3], v[96:111]
    ds_read_b64_tr_b16 a[28:29], v18 offset:26624
    ds_read_b64_tr_b16 a[30:31], v18 offset:27136
    v_mfma_f32_16x16x32_bf16 v[60:63], a[60:63], v[200:203], v[60:63]
    v_mfma_f32_32x32x16_bf16 v[64:79], a[4:7], v[204:207], v[64:79]
    ds_read_b64_tr_b16 a[0:1], v19 offset:26624
    ds_read_b64_tr_b16 a[2:3], v19 offset:27136
    v_mfma_f32_32x32x16_bf16 v[80:95], a[8:11], v[204:207], v[80:95]
    ds_read_b64_tr_b16 a[4:5], v42 offset:37888
    ds_read_b64_tr_b16 a[6:7], v42 offset:38144
    s_waitcnt vmcnt(16)
    ds_read_b128 v[224:227], v52 offset:8192
    v_mfma_f32_32x32x16_bf16 v[96:111], v[204:207], a[12:15], v[96:111]
    ds_read_b64_tr_b16 a[8:9], v20 offset:24576
    ds_read_b64_tr_b16 a[10:11], v20 offset:25088
    ds_read_b128 v[228:231], v53 offset:8192
    v_mfma_f32_16x16x32_bf16 v[60:63], a[60:63], v[204:207], v[60:63]
    ds_read_b128 v[232:235], v54 offset:8192
    v_mfma_f32_4x4x4_16b_bf16 v[112:115], v[192:193], v[192:193], v[112:115]
    v_mfma_f32_4x4x4_16b_bf16 v[116:119], v[194:195], v[194:195], v[116:119]
    v_mfma_f32_4x4x4_16b_bf16 v[120:123], v[196:197], v[196:197], v[120:123]
    v_mfma_f32_4x4x4_16b_bf16 v[124:127], v[198:199], v[198:199], v[124:127]
    v_mfma_f32_4x4x4_16b_bf16 v[112:115], v[200:201], v[200:201], v[112:115]
    v_mfma_f32_4x4x4_16b_bf16 v[116:119], v[202:203], v[202:203], v[116:119]
    v_mfma_f32_4x4x4_16b_bf16 v[120:123], v[204:205], v[204:205], v[120:123]
    v_mfma_f32_4x4x4_16b_bf16 v[124:127], v[206:207], v[206:207], v[124:127]
    s_waitcnt lgkmcnt(9)
    v_mfma_f32_32x32x16_bf16 v[64:79], a[16:19], v[208:211], v[64:79]
    ds_read_b64_tr_b16 a[12:13], v21 offset:24576
    ds_read_b64_tr_b16 a[14:15], v21 offset:25088
    ds_read_b128 v[236:239], v55 offset:8192
    v_mfma_f32_32x32x16_bf16 v[80:95], a[20:23], v[208:211], v[80:95]
    ds_read_b64_tr_b16 a[16:17], v43 offset:36864
    ds_read_b64_tr_b16 a[18:19], v43 offset:37120
    ds_read_b128 v[240:243], v56 offset:8192
    v_mfma_f32_32x32x16_bf16 v[96:111], v[208:211], a[24:27], v[96:111]
    ds_read_b64_tr_b16 a[20:21], v20 offset:26624
    ds_read_b64_tr_b16 a[22:23], v20 offset:27136
    ds_read_b128 v[244:247], v57 offset:8192
    v_mfma_f32_16x16x32_bf16 v[60:63], a[60:63], v[208:211], v[60:63]
    ds_read_b128 v[248:251], v58 offset:8192
    v_mfma_f32_32x32x16_bf16 v[64:79], a[28:31], v[212:215], v[64:79]
    ds_read_b64_tr_b16 a[24:25], v21 offset:26624
    ds_read_b64_tr_b16 a[26:27], v21 offset:27136
    ds_read_b128 v[252:255], v59 offset:8192
    s_waitcnt lgkmcnt(11)
    v_mfma_f32_32x32x16_bf16 v[80:95], a[0:3], v[212:215], v[80:95]
    ds_read_b64_tr_b16 a[28:29], v43 offset:37888
    ds_read_b64_tr_b16 a[30:31], v43 offset:38144
    v_mfma_f32_32x32x16_bf16 v[96:111], v[212:215], a[4:7], v[96:111]
    s_lshr_b32 s41, s2, 4
    s_cmp_eq_u32 s41, 4
    s_cbranch_scc1 Lpub_2e
Lpub_2:
    s_waitcnt vmcnt(10)
    s_barrier
    ds_read_b64_tr_b16 a[0:1], v14 offset:28672
    ds_read_b64_tr_b16 a[2:3], v14 offset:29184
    v_mfma_f32_16x16x32_bf16 v[60:63], a[60:63], v[212:215], v[60:63]
    v_mfma_f32_32x32x16_bf16 v[64:79], a[8:11], v[216:219], v[64:79]
    ds_read_b64_tr_b16 a[4:5], v15 offset:28672
    ds_read_b64_tr_b16 a[6:7], v15 offset:29184
    v_mfma_f32_32x32x16_bf16 v[80:95], a[12:15], v[216:219], v[80:95]
    ds_read_b64_tr_b16 a[8:9], v40 offset:38912
    ds_read_b64_tr_b16 a[10:11], v40 offset:39168
    s_waitcnt lgkmcnt(6)
    v_mfma_f32_32x32x16_bf16 v[96:111], v[216:219], a[16:19], v[96:111]
    ds_read_b64_tr_b16 a[12:13], v14 offset:30720
    ds_read_b64_tr_b16 a[14:15], v14 offset:31232
    v_mfma_f32_16x16x32_bf16 v[60:63], a[60:63], v[216:219], v[60:63]
    v_mfma_f32_32x32x16_bf16 v[64:79], a[20:23], v[220:223], v[64:79]
    ds_read_b64_tr_b16 a[16:17], v15 offset:30720
    ds_read_b64_tr_b16 a[18:19], v15 offset:31232
    v_mfma_f32_32x32x16_bf16 v[80:95], a[24:27], v[220:223], v[80:95]
    ds_read_b64_tr_b16 a[20:21], v40 offset:39936
    ds_read_b64_tr_b16 a[22:23], v40 offset:40192
    v_mfma_f32_32x32x16_bf16 v[96:111], v[220:223], a[28:31], v[96:111]
    ds_read_b64_tr_b16 a[24:25], v16 offset:28672
    ds_read_b64_tr_b16 a[26:27], v16 offset:29184
    v_mfma_f32_16x16x32_bf16 v[60:63], a[60:63], v[220:223], v[60:63]
    v_mfma_f32_4x4x4_16b_bf16 v[112:115], v[208:209], v[208:209], v[112:115]
    v_mfma_f32_4x4x4_16b_bf16 v[116:119], v[210:211], v[210:211], v[116:119]
    v_mfma_f32_4x4x4_16b_bf16 v[120:123], v[212:213], v[212:213], v[120:123]
    v_mfma_f32_4x4x4_16b_bf16 v[124:127], v[214:215], v[214:215], v[124:127]
    v_mfma_f32_4x4x4_16b_bf16 v[112:115], v[216:217], v[216:217], v[112:115]
    v_mfma_f32_4x4x4_16b_bf16 v[116:119], v[218:219], v[218:219], v[116:119]
    v_mfma_f32_4x4x4_16b_bf16 v[120:123], v[220:221], v[220:221], v[120:123]
    v_mfma_f32_4x4x4_16b_bf16 v[124:127], v[222:223], v[222:223], v[124:127]
    s_waitcnt lgkmcnt(6)
    v_mfma_f32_32x32x16_bf16 v[64:79], a[0:3], v[224:227], v[64:79]
    ds_read_b64_tr_b16 a[28:29], v17 offset:28672
    ds_read_b64_tr_b16 a[30:31], v17 offset:29184
    s_add_u32 m0, s39, 8192
    s_mul_i32 s3, s53, 458752
    s_add_u32 s3, s3, s47
    buffer_load_dwordx4 v2, s[12:15], s3 offen offset:0 lds
    v_mfma_f32_16x16x32_bf16 v[32:35], a[32:35], a[0:3], v[32:35]
    v_mfma_f32_32x32x16_bf16 v[80:95], a[4:7], v[224:227], v[80:95]
    ds_read_b64_tr_b16 a[0:1], v41 offset:38912
    ds_read_b64_tr_b16 a[2:3], v41 offset:39168
    buffer_load_dwordx4 v3, s[12:15], s3 offen offset:1024 lds
    v_mfma_f32_16x16x32_bf16 v[32:35], a[36:39], a[4:7], v[32:35]
    v_mfma_f32_32x32x16_bf16 v[96:111], v[224:227], a[8:11], v[96:111]
    ds_read_b64_tr_b16 a[4:5], v16 offset:30720
    ds_read_b64_tr_b16 a[6:7], v16 offset:31232
    buffer_load_dwordx4 v4, s[12:15], s3 offen offset:2048 lds
    v_mfma_f32_16x16x32_bf16 v[10:13], a[32:35], a[8:11], v[10:13]
    v_mfma_f32_16x16x32_bf16 v[60:63], a[60:63], v[224:227], v[60:63]
    buffer_load_dwordx4 v5, s[12:15], s3 offen offset:3072 lds
    v_mfma_f32_16x16x32_bf16 v[60:63], a[60:63], v[228:231], v[60:63]
    s_add_u32 m0, s39, 16384
    s_mul_i32 s49, s43, 458752
    s_add_u32 s49, s49, s47
    buffer_load_dwordx4 v2, s[12:15], s49 offen offset:0 lds
    v_mfma_f32_32x32x16_bf16 v[64:79], a[12:15], v[228:231], v[64:79]
    ds_read_b64_tr_b16 a[8:9], v17 offset:30720
    ds_read_b64_tr_b16 a[10:11], v17 offset:31232
    v_mfma_f32_16x16x32_bf16 v[32:35], a[32:35], a[12:15], v[32:35]
    s_waitcnt lgkmcnt(6)
    v_mfma_f32_32x32x16_bf16 v[80:95], a[16:19], v[228:231], v[80:95]
    ds_read_b64_tr_b16 a[12:13], v41 offset:39936
    ds_read_b64_tr_b16 a[14:15], v41 offset:40192
    buffer_load_dwordx4 v3, s[12:15], s49 offen offset:1024 lds
    v_mfma_f32_16x16x32_bf16 v[32:35], a[36:39], a[16:19], v[32:35]
    v_mfma_f32_32x32x16_bf16 v[96:111], v[228:231], a[20:23], v[96:111]
    ds_read_b64_tr_b16 a[16:17], v18 offset:28672
    ds_read_b64_tr_b16 a[18:19], v18 offset:29184
    buffer_load_dwordx4 v4, s[12:15], s49 offen offset:2048 lds
    v_mfma_f32_16x16x32_bf16 v[10:13], a[32:35], a[20:23], v[10:13]
    v_mfma_f32_16x16x32_bf16 v[60:63], a[60:63], v[232:235], v[60:63]
    v_mfma_f32_16x16x32_bf16 v[60:63], a[60:63], v[236:239], v[60:63]
    v_mfma_f32_4x4x4_16b_bf16 v[112:115], v[224:225], v[224:225], v[112:115]
    v_mfma_f32_4x4x4_16b_bf16 v[116:119], v[226:227], v[226:227], v[116:119]
    buffer_load_dwordx4 v5, s[12:15], s49 offen offset:3072 lds
    v_mfma_f32_4x4x4_16b_bf16 v[120:123], v[228:229], v[228:229], v[120:123]
    s_lshr_b32 s49, s2, 6
    s_cmp_lt_u32 s49, 2
    s_cselect_b32 s49, 2, s49
    s_cselect_b32 s3, 0, 0x80000000
    v_lshrrev_b32 v25, 6, v2
    v_xor_b32 v25, s49, v25
    v_lshlrev_b32 v25, 31, v25
    v_and_b32 v25, s3, v25
    v_or_b32 v2, v25, v2
    v_or_b32 v3, v25, v3
    v_or_b32 v4, v25, v4
    v_or_b32 v5, v25, v5
    v_mfma_f32_4x4x4_16b_bf16 v[124:127], v[230:231], v[230:231], v[124:127]
    s_add_u32 m0, s39, 20480
    v_mfma_f32_4x4x4_16b_bf16 v[112:115], v[232:233], v[232:233], v[112:115]
    s_mul_i32 s49, s0, 458752
    v_mfma_f32_4x4x4_16b_bf16 v[116:119], v[234:235], v[234:235], v[116:119]
    s_add_u32 s49, s49, s48
    v_mfma_f32_4x4x4_16b_bf16 v[120:123], v[236:237], v[236:237], v[120:123]
    v_mfma_f32_4x4x4_16b_bf16 v[124:127], v[238:239], v[238:239], v[124:127]
    v_mfma_f32_32x32x16_bf16 v[64:79], a[24:27], v[232:235], v[64:79]
    ds_read_b64_tr_b16 a[20:21], v19 offset:28672
    ds_read_b64_tr_b16 a[22:23], v19 offset:29184
    buffer_load_dwordx4 v2, s[12:15], s49 offen offset:0 lds
    v_mfma_f32_32x32x16_bf16 v[80:95], a[28:31], v[232:235], v[80:95]
    ds_read_b64_tr_b16 a[24:25], v42 offset:38912
    ds_read_b64_tr_b16 a[26:27], v42 offset:39168
    s_waitcnt lgkmcnt(6)
    v_mfma_f32_32x32x16_bf16 v[96:111], v[232:235], a[0:3], v[96:111]
    ds_read_b64_tr_b16 a[28:29], v18 offset:30720
    ds_read_b64_tr_b16 a[30:31], v18 offset:31232
    v_and_b32 v33, s44, v32
    v_mfma_f32_16x16x32_bf16 v[60:63], a[60:63], v[240:243], v[60:63]
    v_sub_f32 v33, v32, v33
    buffer_load_dwordx4 v3, s[12:15], s49 offen offset:1024 lds
    v_mfma_f32_16x16x32_bf16 v[60:63], a[60:63], v[244:247], v[60:63]
    v_and_b32 v34, s44, v33
    v_mfma_f32_32x32x16_bf16 v[64:79], a[4:7], v[236:239], v[64:79]
    ds_read_b64_tr_b16 a[0:1], v19 offset:30720
    ds_read_b64_tr_b16 a[2:3], v19 offset:31232
    v_sub_f32 v35, v33, v34
    v_mfma_f32_32x32x16_bf16 v[80:95], a[8:11], v[236:239], v[80:95]
    ds_read_b64_tr_b16 a[4:5], v42 offset:39936
    ds_read_b64_tr_b16 a[6:7], v42 offset:40192
    v_perm_b32 v34, v33, v32, s67
    buffer_load_dwordx4 v4, s[12:15], s49 offen offset:2048 lds
    v_mfma_f32_32x32x16_bf16 v[96:111], v[236:239], a[12:15], v[96:111]
    ds_read_b64_tr_b16 a[8:9], v20 offset:28672
    ds_read_b64_tr_b16 a[10:11], v20 offset:29184
    v_perm_b32 v35, 0, v35, s67
    v_mfma_f32_16x16x32_bf16 v[60:63], a[60:63], v[248:251], v[60:63]
    ds_write_b64 v31, v[34:35] offset:12288
    v_mfma_f32_16x16x32_bf16 v[60:63], a[60:63], v[252:255], v[60:63]
    v_and_b32 v11, s44, v10
    v_mfma_f32_4x4x4_16b_bf16 v[112:115], v[240:241], v[240:241], v[112:115]
    v_sub_f32 v11, v10, v11
    buffer_load_dwordx4 v5, s[12:15], s49 offen offset:3072 lds
    v_mfma_f32_4x4x4_16b_bf16 v[116:119], v[242:243], v[242:243], v[116:119]
    v_and_b32 v12, s44, v11
    v_mfma_f32_4x4x4_16b_bf16 v[120:123], v[244:245], v[244:245], v[120:123]
    v_sub_f32 v13, v11, v12
    v_mfma_f32_4x4x4_16b_bf16 v[124:127], v[246:247], v[246:247], v[124:127]
    v_perm_b32 v12, v11, v10, s67
    v_mfma_f32_4x4x4_16b_bf16 v[112:115], v[248:249], v[248:249], v[112:115]
    v_perm_b32 v13, 0, v13, s67
    v_mfma_f32_4x4x4_16b_bf16 v[116:119], v[250:251], v[250:251], v[116:119]
    s_add_u32 m0, s39, 32768
    s_mul_i32 s49, s1, 458752
    v_mfma_f32_4x4x4_16b_bf16 v[120:123], v[252:253], v[252:253], v[120:123]
    s_add_u32 s49, s49, s48
    v_mfma_f32_4x4x4_16b_bf16 v[124:127], v[254:255], v[254:255], v[124:127]
    buffer_load_dwordx4 v2, s[12:15], s49 offen offset:0 lds
    s_waitcnt lgkmcnt(7)
    v_mfma_f32_32x32x16_bf16 v[64:79], a[16:19], v[240:243], v[64:79]
    ds_read_b64_tr_b16 a[12:13], v21 offset:28672
    ds_read_b64_tr_b16 a[14:15], v21 offset:29184
    ds_write_b64 v31, v[12:13] offset:12800
    v_mfma_f32_32x32x16_bf16 v[80:95], a[20:23], v[240:243], v[80:95]
    ds_read_b64_tr_b16 a[16:17], v43 offset:38912
    ds_read_b64_tr_b16 a[18:19], v43 offset:39168
    v_and_b32 v38, 3, v0
    v_pk_add_f32 v[112:113], v[112:113], v[120:121]
    v_pk_add_f32 v[114:115], v[114:115], v[122:123]
    v_pk_add_f32 v[116:117], v[116:117], v[124:125]
    v_pk_add_f32 v[118:119], v[118:119], v[126:127]
    v_mfma_f32_32x32x16_bf16 v[96:111], v[240:243], a[24:27], v[96:111]
    ds_read_b64_tr_b16 a[20:21], v20 offset:30720
    ds_read_b64_tr_b16 a[22:23], v20 offset:31232
    v_add_f32 v112, v112, v116
    v_add_f32 v113, v113, v117
    v_cmp_eq_u32 vcc, 1, v38
    v_add_f32 v114, v114, v118
    buffer_load_dwordx4 v3, s[12:15], s49 offen offset:1024 lds
    v_mfma_f32_32x32x16_bf16 v[64:79], a[28:31], v[244:247], v[64:79]
    ds_read_b64_tr_b16 a[24:25], v21 offset:30720
    ds_read_b64_tr_b16 a[26:27], v21 offset:31232
    v_add_f32 v115, v115, v119
    v_cndmask_b32 v112, v112, v113, vcc
    v_cmp_eq_u32 vcc, 2, v38
    v_cmp_eq_u32 s[40:41], 3, v38
    s_waitcnt lgkmcnt(7)
    v_mfma_f32_32x32x16_bf16 v[80:95], a[0:3], v[244:247], v[80:95]
    ds_read_b64_tr_b16 a[28:29], v43 offset:39936
    ds_read_b64_tr_b16 a[30:31], v43 offset:40192
    v_lshrrev_b32 v38, 5, v0
    v_cndmask_b32 v112, v112, v114, vcc
    v_cndmask_b32 v112, v112, v115, s[40:41]
    v_mov_b32 v113, v112
    v_mul_f32 v36, 0x3b000000, v60
    buffer_load_dwordx4 v4, s[12:15], s49 offen offset:2048 lds
    v_mfma_f32_32x32x16_bf16 v[96:111], v[244:247], a[4:7], v[96:111]
    s_waitcnt vmcnt(19)
    s_waitcnt lgkmcnt(8)
    s_barrier
    ds_read_b64_tr_b16 a[0:1], v14 offset:0
    ds_read_b64_tr_b16 a[2:3], v14 offset:512
    v_permlane32_swap_b32 v112, v113
    v_add_f32 v112, v112, v113
    v_mul_f32 v37, 0x3b000000, v112
    v_fma_f32 v37, -v36, v36, v37
    v_max_f32 v37, 0, v37
    buffer_load_dwordx4 v5, s[12:15], s49 offen offset:3072 lds
    v_mfma_f32_32x32x16_bf16 v[64:79], a[8:11], v[248:251], v[64:79]
    ds_read_b64_tr_b16 a[4:5], v15 offset:0
    ds_read_b64_tr_b16 a[6:7], v15 offset:512
    ds_read_b64 a[44:45], v30 offset:12288
    ds_read_b64 a[46:47], v30 offset:53248
    v_cvt_pk_bf16_f32 v36, -v36, v37
    v_and_b32 v37, s44, v36
    v_add_f32 v37, 0x3727c5ac, v37
    v_cvt_pk_bf16_f32 v37, v37, v37
    v_lshrrev_b32 v11, 3, v0
    v_and_b32 v10, 0x70, v1
    v_lshl_add_u32 v10, v11, 10, v10
    v_and_b32 v11, 16, v0
    v_lshlrev_b32 v11, 2, v11
    v_xor_b32 v10, v11, v10
    v_add_u32 v11, 7168, v10
    v_add_u32 v12, 14336, v10
    v_add_u32 v13, 21504, v10
    s_add_u32 m0, s39, 24576
    s_mul_i32 s49, s53, 458752
    s_add_u32 s49, s49, s48
    v_mfma_f32_32x32x16_bf16 v[80:95], a[12:15], v[248:251], v[80:95]
    ds_read_b64_tr_b16 a[8:9], v14 offset:2048
    ds_read_b64_tr_b16 a[10:11], v14 offset:2560
    ds_read_b64 a[48:49], v30 offset:12544
    v_and_b32 v37, s44, v37
    v_sqrt_f32 v37, v37
    v_and_b32 v36, 0xffff, v36
    v_cvt_pk_bf16_f32 v37, v37, v37
    buffer_load_dwordx4 v2, s[12:15], s49 offen offset:0 lds
    s_waitcnt lgkmcnt(9)
    v_mfma_f32_32x32x16_bf16 v[96:111], v[248:251], a[16:19], v[96:111]
    ds_read_b64_tr_b16 a[12:13], v15 offset:2048
    ds_read_b64_tr_b16 a[14:15], v15 offset:2560
    ds_read_b64 a[50:51], v30 offset:53504
    v_and_b32 v37, s44, v37
    v_rcp_f32 v28, v37
    v_cmp_eq_u32 vcc, 0, v38
    buffer_load_dwordx4 v3, s[12:15], s49 offen offset:1024 lds
    v_mfma_f32_32x32x16_bf16 v[64:79], a[20:23], v[252:255], v[64:79]
    ds_read_b64_tr_b16 a[16:17], v16 offset:0
    ds_read_b64_tr_b16 a[18:19], v16 offset:512
    ds_read_b64 a[128:129], v30 offset:12800
    v_lshl_or_b32 v39, v36, 16, v36
    v_cndmask_b32 v37, 0, v37, vcc
    v_accvgpr_write_b32 a40, v39
    v_or_b32 v37, v37, v36
    v_accvgpr_write_b32 a42, v39
    v_mfma_f32_32x32x16_bf16 v[80:95], a[24:27], v[252:255], v[80:95]
    ds_read_b64_tr_b16 a[20:21], v17 offset:0
    ds_read_b64_tr_b16 a[22:23], v17 offset:512
    ds_read_b64 a[130:131], v30 offset:53760
    v_accvgpr_write_b32 a41, v37
    v_accvgpr_write_b32 a43, v36
    v_mul_f32 v29, s56, v28
    v_and_b32 v36, 31, v0
    v_lshlrev_b32 v36, 2, v36
    v_mfma_f32_32x32x16_bf16 v[96:111], v[252:255], a[28:31], v[96:111]
    ds_read_b64_tr_b16 a[24:25], v16 offset:2048
    ds_read_b64_tr_b16 a[26:27], v16 offset:2560
    v_add_u32 v36, s39, v36
    ds_write_b32 v36, v28 offset:14336
    buffer_load_dwordx4 v4, s[12:15], s49 offen offset:2048 lds
    s_waitcnt lgkmcnt(15)
    v_mfma_f32_32x32x16_bf16 v[64:79], a[44:47], a[40:43], v[64:79]
    s_waitcnt lgkmcnt(9)
    v_mfma_f32_32x32x16_bf16 v[80:95], a[48:51], a[40:43], v[80:95]
    s_waitcnt lgkmcnt(3)
    v_mfma_f32_32x32x16_bf16 v[96:111], a[40:43], a[128:131], v[96:111]
    buffer_load_dwordx4 v5, s[12:15], s49 offen offset:3072 lds
    v_mfma_f32_32x32x16_bf16 v[112:127], a[0:3], v[128:131], 0
    ds_read_b64_tr_b16 a[28:29], v17 offset:2048
    ds_read_b64_tr_b16 a[30:31], v17 offset:2560
    v_mfma_f32_16x16x32_bf16 v[32:35], a[32:35], a[0:3], 0
    v_mfma_f32_32x32x16_bf16 a[112:127], a[4:7], v[128:131], 0
    ds_read_b64_tr_b16 a[0:1], v18 offset:0
    ds_read_b64_tr_b16 a[2:3], v18 offset:512
    v_lshrrev_b32 v45, 5, v0
    v_lshlrev_b32 v45, 4, v45
    v_add_u32 v45, s39, v45
    v_mfma_f32_16x16x32_bf16 v[32:35], a[36:39], a[4:7], v[32:35]
    ds_read_b128 v[48:51], v45 offset:14336
    ds_read_b128 v[52:55], v45 offset:14368
    v_mfma_f32_32x32x16_bf16 v[112:127], a[8:11], v[132:135], v[112:127]
    ds_read_b64_tr_b16 a[4:5], v19 offset:0
    ds_read_b64_tr_b16 a[6:7], v19 offset:512
    ds_read_b128 v[56:59], v45 offset:14400
    ds_read_b128 v[60:63], v45 offset:14432
    v_mfma_f32_16x16x32_bf16 v[32:35], a[32:35], a[8:11], v[32:35]
    v_mul_f32 v64, v29, v64
    v_mul_f32 v65, v29, v65
    v_cvt_pk_bf16_f32 v36, v64, v65
    v_mul_f32 v66, v29, v66
    v_mfma_f32_32x32x16_bf16 a[112:127], a[12:15], v[132:135], a[112:127]
    ds_read_b64_tr_b16 a[8:9], v18 offset:2048
    ds_read_b64_tr_b16 a[10:11], v18 offset:2560
    v_mul_f32 v67, v29, v67
    v_cvt_pk_bf16_f32 v37, v66, v67
    v_mul_f32 v68, v29, v68
    v_mul_f32 v69, v29, v69
    v_mfma_f32_16x16x32_bf16 v[32:35], a[36:39], a[12:15], v[32:35]
    v_cvt_pk_bf16_f32 v38, v68, v69
    v_mul_f32 v70, v29, v70
    v_mul_f32 v71, v29, v71
    v_cvt_pk_bf16_f32 v39, v70, v71
    s_waitcnt lgkmcnt(10)
    v_mfma_f32_32x32x16_bf16 v[112:127], a[16:19], v[136:139], v[112:127]
    ds_read_b64_tr_b16 a[12:13], v19 offset:2048
    ds_read_b64_tr_b16 a[14:15], v19 offset:2560
    s_add_u32 s41, s50, 196608
    buffer_store_dwordx4 v[36:39], v1, s[24:27], s41 offen sc1
    v_mfma_f32_32x32x16_bf16 a[112:127], a[20:23], v[136:139], a[112:127]
    ds_read_b64_tr_b16 a[16:17], v20 offset:0
    ds_read_b64_tr_b16 a[18:19], v20 offset:512
    v_mul_f32 v72, v29, v72
    v_mul_f32 v73, v29, v73
    v_cvt_pk_bf16_f32 v40, v72, v73
    v_mul_f32 v74, v29, v74
    v_mfma_f32_32x32x16_bf16 v[112:127], a[24:27], v[140:143], v[112:127]
    ds_read_b64_tr_b16 a[20:21], v21 offset:0
    ds_read_b64_tr_b16 a[22:23], v21 offset:512
    v_mul_f32 v75, v29, v75
    v_cvt_pk_bf16_f32 v41, v74, v75
    v_mul_f32 v76, v29, v76
    v_mul_f32 v77, v29, v77
    v_mfma_f32_32x32x16_bf16 a[112:127], a[28:31], v[140:143], a[112:127]
    ds_read_b64_tr_b16 a[24:25], v20 offset:2048
    ds_read_b64_tr_b16 a[26:27], v20 offset:2560
    v_cvt_pk_bf16_f32 v42, v76, v77
    v_mul_f32 v78, v29, v78
    v_mul_f32 v79, v29, v79
    v_cvt_pk_bf16_f32 v43, v78, v79
    s_waitcnt lgkmcnt(6)
    v_mfma_f32_32x32x16_bf16 v[112:127], a[0:3], v[144:147], v[112:127]
    ds_read_b64_tr_b16 a[28:29], v21 offset:2048
    ds_read_b64_tr_b16 a[30:31], v21 offset:2560
    s_add_u32 s41, s50, 262144
    buffer_store_dwordx4 v[40:43], v1, s[24:27], s41 offen sc1
    v_mfma_f32_32x32x16_bf16 a[112:127], a[4:7], v[144:147], a[112:127]
    s_waitcnt vmcnt(22)
    s_barrier
    ds_read_b64_tr_b16 a[0:1], v14 offset:4096
    ds_read_b64_tr_b16 a[2:3], v14 offset:4608
    v_mul_f32 v80, v29, v80
    v_mul_f32 v81, v29, v81
    v_cvt_pk_bf16_f32 v36, v80, v81
    v_mul_f32 v82, v29, v82
    s_add_u32 m0, s39, 28672
    s_mul_i32 s49, s43, 458752
    s_add_u32 s49, s49, s48
    v_mfma_f32_32x32x16_bf16 v[112:127], a[8:11], v[148:151], v[112:127]
    ds_read_b64_tr_b16 a[4:5], v15 offset:4096
    ds_read_b64_tr_b16 a[6:7], v15 offset:4608
    v_mul_f32 v83, v29, v83
    v_cvt_pk_bf16_f32 v37, v82, v83
    v_mul_f32 v84, v29, v84
    v_mul_f32 v85, v29, v85
    buffer_load_dwordx4 v2, s[12:15], s49 offen offset:0 lds
    v_mfma_f32_32x32x16_bf16 a[112:127], a[12:15], v[148:151], a[112:127]
    ds_read_b64_tr_b16 a[8:9], v14 offset:6144
    ds_read_b64_tr_b16 a[10:11], v14 offset:6656
    v_cvt_pk_bf16_f32 v38, v84, v85
    v_mul_f32 v86, v29, v86
    v_mul_f32 v87, v29, v87
    v_cvt_pk_bf16_f32 v39, v86, v87
    s_waitcnt lgkmcnt(6)
    v_mfma_f32_32x32x16_bf16 v[112:127], a[16:19], v[152:155], v[112:127]
    ds_read_b64_tr_b16 a[12:13], v15 offset:6144
    ds_read_b64_tr_b16 a[14:15], v15 offset:6656
    s_add_u32 s41, s50, 327680
    buffer_store_dwordx4 v[36:39], v1, s[24:27], s41 offen sc1
    v_mfma_f32_32x32x16_bf16 a[112:127], a[20:23], v[152:155], a[112:127]
    ds_read_b64_tr_b16 a[16:17], v16 offset:4096
    ds_read_b64_tr_b16 a[18:19], v16 offset:4608
    v_mul_f32 v88, v29, v88
    v_mul_f32 v89, v29, v89
    v_cvt_pk_bf16_f32 v40, v88, v89
    v_mul_f32 v90, v29, v90
    buffer_load_dwordx4 v3, s[12:15], s49 offen offset:1024 lds
    v_mfma_f32_32x32x16_bf16 v[112:127], a[24:27], v[156:159], v[112:127]
    ds_read_b64_tr_b16 a[20:21], v17 offset:4096
    ds_read_b64_tr_b16 a[22:23], v17 offset:4608
    v_mul_f32 v91, v29, v91
    v_cvt_pk_bf16_f32 v41, v90, v91
    v_mul_f32 v92, v29, v92
    v_mul_f32 v93, v29, v93
    v_mfma_f32_32x32x16_bf16 a[112:127], a[28:31], v[156:159], a[112:127]
    ds_read_b64_tr_b16 a[24:25], v16 offset:6144
    ds_read_b64_tr_b16 a[26:27], v16 offset:6656
    v_cvt_pk_bf16_f32 v42, v92, v93
    v_mul_f32 v94, v29, v94
    v_mul_f32 v95, v29, v95
    v_cvt_pk_bf16_f32 v43, v94, v95
    buffer_load_dwordx4 v4, s[12:15], s49 offen offset:2048 lds
    s_waitcnt lgkmcnt(6)
    v_mfma_f32_32x32x16_bf16 v[112:127], a[0:3], v[160:163], v[112:127]
    ds_read_b64_tr_b16 a[28:29], v17 offset:6144
    ds_read_b64_tr_b16 a[30:31], v17 offset:6656
    s_add_u32 s41, s50, 393216
    buffer_store_dwordx4 v[40:43], v1, s[24:27], s41 offen sc1
    v_mfma_f32_16x16x32_bf16 v[32:35], a[32:35], a[0:3], v[32:35]
    v_mul_f32 v96, v48, v96
    v_mul_f32 v97, v49, v97
    v_cvt_pk_bf16_f32 v36, v96, v97
    v_mul_f32 v98, v50, v98
    buffer_load_dwordx4 v5, s[12:15], s49 offen offset:3072 lds
    v_mfma_f32_32x32x16_bf16 a[112:127], a[4:7], v[160:163], a[112:127]
    ds_read_b64_tr_b16 a[0:1], v18 offset:4096
    ds_read_b64_tr_b16 a[2:3], v18 offset:4608
    v_mul_f32 v99, v51, v99
    v_cvt_pk_bf16_f32 v37, v98, v99
    v_mul_f32 v100, v52, v100
    v_mul_f32 v101, v53, v101
    s_add_u32 m0, s39, 36864
    s_add_u32 s49, s58, 0
    v_mfma_f32_16x16x32_bf16 v[32:35], a[36:39], a[4:7], v[32:35]
    v_cvt_pk_bf16_f32 v38, v100, v101
    v_mul_f32 v102, v54, v102
    v_mul_f32 v103, v55, v103
    v_cvt_pk_bf16_f32 v39, v102, v103
    buffer_load_dwordx4 v10, s[20:23], s49 offen offset:0 lds
    v_mfma_f32_32x32x16_bf16 v[112:127], a[8:11], v[164:167], v[112:127]
    ds_read_b64_tr_b16 a[4:5], v19 offset:4096
    ds_read_b64_tr_b16 a[6:7], v19 offset:4608
    buffer_store_dwordx4 v[36:39], v24, s[24:27], s51 offen offset:0 sc1
    v_mfma_f32_16x16x32_bf16 v[32:35], a[32:35], a[8:11], v[32:35]
    v_mul_f32 v104, v56, v104
    v_mul_f32 v105, v57, v105
    v_cvt_pk_bf16_f32 v40, v104, v105
    v_mul_f32 v106, v58, v106
    v_mfma_f32_32x32x16_bf16 a[112:127], a[12:15], v[164:167], a[112:127]
    ds_read_b64_tr_b16 a[8:9], v18 offset:6144
    ds_read_b64_tr_b16 a[10:11], v18 offset:6656
    v_mul_f32 v107, v59, v107
    v_cvt_pk_bf16_f32 v41, v106, v107
    v_mul_f32 v108, v60, v108
    v_mul_f32 v109, v61, v109
    buffer_load_dwordx4 v11, s[20:23], s49 offen offset:1024 lds
    v_mfma_f32_16x16x32_bf16 v[32:35], a[36:39], a[12:15], v[32:35]
    v_cvt_pk_bf16_f32 v42, v108, v109
    v_mul_f32 v110, v62, v110
    v_mul_f32 v111, v63, v111
    v_cvt_pk_bf16_f32 v43, v110, v111
    s_waitcnt lgkmcnt(6)
    v_mfma_f32_32x32x16_bf16 v[112:127], a[16:19], v[168:171], v[112:127]
    ds_read_b64_tr_b16 a[12:13], v19 offset:6144
    ds_read_b64_tr_b16 a[14:15], v19 offset:6656
    v_lshlrev_b32 v26, 2, v0
    global_load_dword v25, v26, s[36:37] sc1
    buffer_store_dwordx4 v[40:43], v24, s[24:27], s51 offen offset:256 sc1
    v_mfma_f32_32x32x16_bf16 a[112:127], a[20:23], v[168:171], a[112:127]
    ds_read_b64_tr_b16 a[16:17], v20 offset:4096
    ds_read_b64_tr_b16 a[18:19], v20 offset:4608
    buffer_load_dwordx4 v12, s[20:23], s49 offen offset:2048 lds
    s_lshl_b32 s9, s62, 11
    v_mfma_f32_32x32x16_bf16 v[112:127], a[24:27], v[172:175], v[112:127]
    ds_read_b64_tr_b16 a[20:21], v21 offset:4096
    ds_read_b64_tr_b16 a[22:23], v21 offset:4608
    s_add_u32 s9, s9, s60
    s_add_u32 s9, s9, 196608
    s_lshr_b32 s4, s2, 5
    v_mfma_f32_32x32x16_bf16 a[112:127], a[28:31], v[172:175], a[112:127]
    ds_read_b64_tr_b16 a[24:25], v20 offset:6144
    ds_read_b64_tr_b16 a[26:27], v20 offset:6656
    s_lshl1_add_u32 s4, s4, s38
    s_lshl_b32 s5, s4, 12
    s_waitcnt lgkmcnt(6)
    v_mfma_f32_32x32x16_bf16 v[112:127], a[0:3], v[176:179], v[112:127]
    ds_read_b64_tr_b16 a[28:29], v21 offset:6144
    ds_read_b64_tr_b16 a[30:31], v21 offset:6656
    buffer_load_dwordx4 v13, s[20:23], s49 offen offset:3072 lds
    v_mfma_f32_32x32x16_bf16 a[112:127], a[4:7], v[176:179], a[112:127]
    s_waitcnt vmcnt(31)
    s_barrier
    ds_read_b64_tr_b16 a[0:1], v14 offset:8192
    ds_read_b64_tr_b16 a[2:3], v14 offset:8704
    s_add_u32 m0, s39, 0
    v_mfma_f32_32x32x16_bf16 v[112:127], a[8:11], v[180:183], v[112:127]
    ds_read_b64_tr_b16 a[4:5], v15 offset:8192
    ds_read_b64_tr_b16 a[6:7], v15 offset:8704
    s_add_u32 s49, s58, 32768
    buffer_load_dwordx4 v10, s[20:23], s49 offen offset:0 lds
    v_mfma_f32_32x32x16_bf16 a[112:127], a[12:15], v[180:183], a[112:127]
    ds_read_b64_tr_b16 a[8:9], v14 offset:10240
    ds_read_b64_tr_b16 a[10:11], v14 offset:10752
    s_add_u32 s5, s5, s60
    s_add_u32 s5, s5, 2285568
    s_waitcnt lgkmcnt(6)
    v_mfma_f32_32x32x16_bf16 v[112:127], a[16:19], v[184:187], v[112:127]
    ds_read_b64_tr_b16 a[12:13], v15 offset:10240
    ds_read_b64_tr_b16 a[14:15], v15 offset:10752
    buffer_load_dwordx4 v11, s[20:23], s49 offen offset:1024 lds
    v_mfma_f32_32x32x16_bf16 a[112:127], a[20:23], v[184:187], a[112:127]
    ds_read_b64_tr_b16 a[16:17], v16 offset:8192
    ds_read_b64_tr_b16 a[18:19], v16 offset:8704
    s_cmp_lt_u32 s4, 2
    s_cselect_b32 s5, 0x80000000, s5
    s_cselect_b32 s4, 0, 0x3f803f80
    v_mfma_f32_32x32x16_bf16 v[112:127], a[24:27], v[188:191], v[112:127]
    ds_read_b64_tr_b16 a[20:21], v17 offset:8192
    ds_read_b64_tr_b16 a[22:23], v17 offset:8704
    v_mov_b32 v56, s4
    v_mov_b32 v57, s4
    v_mov_b64 v[58:59], v[56:57]
    v_mfma_f32_32x32x16_bf16 a[112:127], a[28:31], v[188:191], a[112:127]
    ds_read_b64_tr_b16 a[24:25], v16 offset:10240
    ds_read_b64_tr_b16 a[26:27], v16 offset:10752
    v_and_b32 v51, 1, v0
    v_and_b32 v52, 2, v0
    s_waitcnt lgkmcnt(6)
    v_mfma_f32_32x32x16_bf16 v[112:127], a[0:3], v[192:195], v[112:127]
    ds_read_b64_tr_b16 a[28:29], v17 offset:10240
    ds_read_b64_tr_b16 a[30:31], v17 offset:10752
    buffer_load_dwordx4 v12, s[20:23], s49 offen offset:2048 lds
    v_mfma_f32_16x16x32_bf16 v[32:35], a[32:35], a[0:3], v[32:35]
    v_lshlrev_b32 v51, 8, v51
    v_lshl_add_u32 v51, v52, 9, v51
    v_add_u32 v51, s39, v51
    v_mfma_f32_32x32x16_bf16 a[112:127], a[4:7], v[192:195], a[112:127]
    ds_read_b64_tr_b16 a[0:1], v18 offset:8192
    ds_read_b64_tr_b16 a[2:3], v18 offset:8704
    buffer_load_dwordx4 v13, s[20:23], s49 offen offset:3072 lds
    v_mfma_f32_16x16x32_bf16 v[32:35], a[36:39], a[4:7], v[32:35]
    ds_write_b128 v51, v[56:59] offset:14848
    v_mfma_f32_32x32x16_bf16 v[112:127], a[8:11], v[196:199], v[112:127]
    ds_read_b64_tr_b16 a[4:5], v19 offset:8192
    ds_read_b64_tr_b16 a[6:7], v19 offset:8704
    v_and_b32 v53, 16, v0
    v_cmp_eq_u32 s[6:7], 0, v53
    s_lshr_b32 s4, s38, 1
    v_mfma_f32_16x16x32_bf16 v[32:35], a[32:35], a[8:11], v[32:35]
    s_mul_i32 s4, s4, 40960
    s_add_u32 s40, s4, 10752
    v_mov_b32 v51, s40
    v_mfma_f32_32x32x16_bf16 a[112:127], a[12:15], v[196:199], a[112:127]
    ds_read_b64_tr_b16 a[8:9], v18 offset:10240
    ds_read_b64_tr_b16 a[10:11], v18 offset:10752
    s_and_b32 s40, s38, 1
    s_lshl_b32 s40, s40, 11
    s_add_u32 s4, s4, s40
    v_mfma_f32_16x16x32_bf16 v[32:35], a[36:39], a[12:15], v[32:35]
    s_add_u32 s4, s4, 16384
    v_add_u32 v48, s4, v1
    s_waitcnt lgkmcnt(7)
    v_mfma_f32_32x32x16_bf16 v[112:127], a[16:19], v[200:203], v[112:127]
    ds_read_b64_tr_b16 a[12:13], v19 offset:10240
    ds_read_b64_tr_b16 a[14:15], v19 offset:10752
    v_add_u32 v50, 81920, v48
    v_cndmask_b32 v51, v51, v48, s[6:7]
    v_add_u32 v53, 81920, v51
    v_mfma_f32_32x32x16_bf16 a[112:127], a[20:23], v[200:203], a[112:127]
    ds_read_b64_tr_b16 a[16:17], v20 offset:8192
    ds_read_b64_tr_b16 a[18:19], v20 offset:8704
    s_add_u32 s4, s38, 1
    s_and_b32 s40, s4, 1
    s_lshr_b32 s4, s4, 1
    v_mfma_f32_32x32x16_bf16 v[112:127], a[24:27], v[204:207], v[112:127]
    ds_read_b64_tr_b16 a[20:21], v21 offset:8192
    ds_read_b64_tr_b16 a[22:23], v21 offset:8704
    s_mul_i32 s4, s4, 40960
    s_lshl_b32 s40, s40, 11
    s_add_u32 s40, s40, s4
    v_mfma_f32_32x32x16_bf16 a[112:127], a[28:31], v[204:207], a[112:127]
    ds_read_b64_tr_b16 a[24:25], v20 offset:10240
    ds_read_b64_tr_b16 a[26:27], v20 offset:10752
    s_add_u32 s40, s40, 16384
    v_add_u32 v49, s40, v1
    s_waitcnt lgkmcnt(6)
    v_mfma_f32_32x32x16_bf16 v[112:127], a[0:3], v[208:211], v[112:127]
    ds_read_b64_tr_b16 a[28:29], v21 offset:10240
    ds_read_b64_tr_b16 a[30:31], v21 offset:10752
    s_add_u32 s4, s4, 10752
    v_mov_b32 v52, s4
    v_cndmask_b32 v52, v52, v49, s[6:7]
    v_mfma_f32_32x32x16_bf16 a[112:127], a[4:7], v[208:211], a[112:127]
    s_waitcnt vmcnt(31)
    s_barrier
    ds_read_b64_tr_b16 a[0:1], v14 offset:16384
    ds_read_b64_tr_b16 a[2:3], v14 offset:16896
    s_add_u32 m0, s39, 4096
    s_add_u32 s49, s58, 65536
    buffer_load_dwordx4 v10, s[20:23], s49 offen offset:0 lds
    v_mfma_f32_32x32x16_bf16 v[112:127], a[8:11], v[212:215], v[112:127]
    ds_read_b64_tr_b16 a[4:5], v15 offset:16384
    ds_read_b64_tr_b16 a[6:7], v15 offset:16896
    s_waitcnt vmcnt(8)
    v_cmp_gt_u32 vcc, 1, v25
    s_cbranch_vccnz Lretry_4e
Lok_3:
    v_mfma_f32_32x32x16_bf16 a[112:127], a[12:15], v[212:215], a[112:127]
    ds_read_b64_tr_b16 a[8:9], v14 offset:18432
    ds_read_b64_tr_b16 a[10:11], v14 offset:18944
    buffer_load_dwordx4 v11, s[20:23], s49 offen offset:1024 lds
    s_waitcnt lgkmcnt(6)
    v_mfma_f32_32x32x16_bf16 v[112:127], a[16:19], v[216:219], v[112:127]
    ds_read_b64_tr_b16 a[12:13], v15 offset:18432
    ds_read_b64_tr_b16 a[14:15], v15 offset:18944
    s_waitcnt vmcnt(8)
    v_mov_b32 v25, 1
    s_mov_b64 exec, 1
    buffer_store_dword v25, off, s[24:27], s63 sc1
    s_mov_b64 exec, -1
    v_mfma_f32_32x32x16_bf16 a[112:127], a[20:23], v[216:219], a[112:127]
    ds_read_b64_tr_b16 a[16:17], v16 offset:16384
    ds_read_b64_tr_b16 a[18:19], v16 offset:16896
    buffer_load_dwordx4 v12, s[20:23], s49 offen offset:2048 lds
    v_mfma_f32_32x32x16_bf16 v[112:127], a[24:27], v[220:223], v[112:127]
    ds_read_b64_tr_b16 a[20:21], v17 offset:16384
    ds_read_b64_tr_b16 a[22:23], v17 offset:16896
    v_cndmask_b32 v56, 0, -1, s[68:69]
    v_cndmask_b32 v44, 0, -1, s[70:71]
    s_lshr_b32 s40, s2, 5
    v_mfma_f32_32x32x16_bf16 a[112:127], a[28:31], v[220:223], a[112:127]
    ds_read_b64_tr_b16 a[24:25], v16 offset:18432
    ds_read_b64_tr_b16 a[26:27], v16 offset:18944
    v_perm_b32 v56, v44, v56, s67
    v_cndmask_b32 v57, 0, -1, s[72:73]
    s_waitcnt lgkmcnt(6)
    v_mfma_f32_32x32x16_bf16 v[112:127], a[0:3], v[224:227], v[112:127]
    ds_read_b64_tr_b16 a[28:29], v17 offset:18432
    ds_read_b64_tr_b16 a[30:31], v17 offset:18944
    buffer_load_dwordx4 v13, s[20:23], s49 offen offset:3072 lds
    v_mfma_f32_16x16x32_bf16 v[32:35], a[32:35], a[0:3], v[32:35]
    v_cndmask_b32 v44, 0, -1, s[74:75]
    v_perm_b32 v57, v44, v57, s67
    v_mfma_f32_32x32x16_bf16 a[112:127], a[4:7], v[224:227], a[112:127]
    ds_read_b64_tr_b16 a[0:1], v18 offset:16384
    ds_read_b64_tr_b16 a[2:3], v18 offset:16896
    v_cndmask_b32 v58, 0, -1, s[76:77]
    v_cndmask_b32 v44, 0, -1, s[78:79]
    s_lshl_b32 s40, s40, 1
    v_mfma_f32_16x16x32_bf16 v[32:35], a[36:39], a[4:7], v[32:35]
    v_perm_b32 v58, v44, v58, s67
    v_cndmask_b32 v59, 0, -1, s[80:81]
    v_mfma_f32_32x32x16_bf16 v[112:127], a[8:11], v[228:231], v[112:127]
    ds_read_b64_tr_b16 a[4:5], v19 offset:16384
    ds_read_b64_tr_b16 a[6:7], v19 offset:16896
    v_cndmask_b32 v44, 0, -1, s[82:83]
    v_perm_b32 v59, v44, v59, s67
    s_sub_u32 s40, s40, 2
    v_mfma_f32_16x16x32_bf16 v[32:35], a[32:35], a[8:11], v[32:35]
    v_cndmask_b32 v60, 0, -1, s[84:85]
    v_cndmask_b32 v44, 0, -1, s[86:87]
    v_mfma_f32_32x32x16_bf16 a[112:127], a[12:15], v[228:231], a[112:127]
    ds_read_b64_tr_b16 a[8:9], v18 offset:18432
    ds_read_b64_tr_b16 a[10:11], v18 offset:18944
    v_perm_b32 v60, v44, v60, s67
    v_cndmask_b32 v61, 0, -1, s[88:89]
    v_bfe_u32 v26, v0, 3, 2
    v_mfma_f32_16x16x32_bf16 v[32:35], a[36:39], a[12:15], v[32:35]
    v_cndmask_b32 v44, 0, -1, s[90:91]
    v_perm_b32 v61, v44, v61, s67
    s_waitcnt lgkmcnt(6)
    v_mfma_f32_32x32x16_bf16 v[112:127], a[16:19], v[232:235], v[112:127]
    ds_read_b64_tr_b16 a[12:13], v19 offset:18432
    ds_read_b64_tr_b16 a[14:15], v19 offset:18944
    v_cndmask_b32 v62, 0, -1, s[92:93]
    v_cndmask_b32 v44, 0, -1, s[94:95]
    v_add_u32 v26, s40, v26
    v_mfma_f32_32x32x16_bf16 a[112:127], a[20:23], v[232:235], a[112:127]
    ds_read_b64_tr_b16 a[16:17], v20 offset:16384
    ds_read_b64_tr_b16 a[18:19], v20 offset:16896
    v_and_b32 v33, s44, v32
    v_sub_f32 v33, v32, v33
    v_perm_b32 v62, v44, v62, s67
    v_mfma_f32_32x32x16_bf16 v[112:127], a[24:27], v[236:239], v[112:127]
    ds_read_b64_tr_b16 a[20:21], v21 offset:16384
    ds_read_b64_tr_b16 a[22:23], v21 offset:16896
    v_and_b32 v34, s44, v33
    v_sub_f32 v35, v33, v34
    v_cndmask_b32 v63, 0, -1, s[96:97]
    v_mfma_f32_32x32x16_bf16 a[112:127], a[28:31], v[236:239], a[112:127]
    ds_read_b64_tr_b16 a[24:25], v20 offset:18432
    ds_read_b64_tr_b16 a[26:27], v20 offset:18944
    v_perm_b32 v34, v33, v32, s67
    v_perm_b32 v35, v46, v35, s67
    s_waitcnt lgkmcnt(6)
    v_mfma_f32_32x32x16_bf16 v[112:127], a[0:3], v[240:243], v[112:127]
    ds_read_b64_tr_b16 a[28:29], v21 offset:18432
    ds_read_b64_tr_b16 a[30:31], v21 offset:18944
    ds_write_b64 v31, v[34:35] offset:13312
    v_mfma_f32_32x32x16_bf16 a[112:127], a[4:7], v[240:243], a[112:127]
    s_waitcnt lgkmcnt(0)
    s_barrier
    ds_read_b64_tr_b16 a[0:1], v14 offset:20480
    ds_read_b64_tr_b16 a[2:3], v14 offset:20992
    s_add_u32 m0, s39, 8192
    s_add_u32 s49, s58, 98304
    v_mfma_f32_32x32x16_bf16 v[112:127], a[8:11], v[244:247], v[112:127]
    ds_read_b64_tr_b16 a[4:5], v15 offset:20480
    ds_read_b64_tr_b16 a[6:7], v15 offset:20992
    ds_read_b64 a[44:45], v30 offset:13312
    buffer_load_dwordx4 v10, s[20:23], s49 offen offset:0 lds
    v_mfma_f32_32x32x16_bf16 a[112:127], a[12:15], v[244:247], a[112:127]
    ds_read_b64_tr_b16 a[8:9], v14 offset:22528
    ds_read_b64_tr_b16 a[10:11], v14 offset:23040
    ds_read_b64 a[46:47], v30 offset:54272
    v_mfma_f32_32x32x16_bf16 v[112:127], a[16:19], v[248:251], v[112:127]
    ds_read_b64_tr_b16 a[12:13], v15 offset:22528
    ds_read_b64_tr_b16 a[14:15], v15 offset:23040
    ds_read_b64 a[48:49], v30 offset:13568
    buffer_load_dwordx4 v11, s[20:23], s49 offen offset:1024 lds
    v_mfma_f32_32x32x16_bf16 a[112:127], a[20:23], v[248:251], a[112:127]
    ds_read_b64_tr_b16 a[16:17], v16 offset:20480
    ds_read_b64_tr_b16 a[18:19], v16 offset:20992
    ds_read_b64 a[50:51], v30 offset:54528
    v_cndmask_b32 v44, 0, -1, s[98:99]
    v_mfma_f32_32x32x16_bf16 v[112:127], a[24:27], v[252:255], v[112:127]
    ds_read_b64_tr_b16 a[20:21], v17 offset:20480
    ds_read_b64_tr_b16 a[22:23], v17 offset:20992
    buffer_load_dwordx4 v12, s[20:23], s49 offen offset:2048 lds
    v_mfma_f32_32x32x16_bf16 a[112:127], a[28:31], v[252:255], a[112:127]
    ds_read_b64_tr_b16 a[24:25], v16 offset:22528
    ds_read_b64_tr_b16 a[26:27], v16 offset:23040
    v_perm_b32 v63, v44, v63, s67
    v_max_i32 v26, 0, v26
    s_waitcnt lgkmcnt(10)
    v_mfma_f32_32x32x16_bf16 v[112:127], a[44:47], a[40:43], v[112:127]
    v_lshlrev_b32 v26, 11, v26
    s_waitcnt lgkmcnt(4)
    v_mfma_f32_32x32x16_bf16 a[112:127], a[48:51], a[40:43], a[112:127]
    buffer_load_dwordx4 v13, s[20:23], s49 offen offset:3072 lds
    v_and_b32 v45, 4, v0
    v_mfma_f32_32x32x16_bf16 v[64:79], a[0:3], v[128:131], 0
    ds_read_b64_tr_b16 a[28:29], v17 offset:22528
    ds_read_b64_tr_b16 a[30:31], v17 offset:23040
    s_waitcnt vmcnt(13)
    ds_read_b64_tr_b16 a[192:193], v22 offset:36864
    v_mfma_f32_16x16x32_bf16 v[32:35], a[32:35], a[0:3], 0
    ds_read_b64_tr_b16 a[194:195], v22 offset:37888
    v_lshl_add_u32 v26, v45, 5, v26
    v_mfma_f32_32x32x16_bf16 v[80:95], a[4:7], v[128:131], 0
    ds_read_b64_tr_b16 a[0:1], v18 offset:20480
    ds_read_b64_tr_b16 a[2:3], v18 offset:20992
    ds_read_b64_tr_b16 a[196:197], v23 offset:36864
    v_and_b32 v45, 3, v0
    v_mul_f32 v112, v28, v112
    v_mul_f32 v113, v28, v113
    v_mul_f32 v112, abs(v112), v112
    v_mfma_f32_16x16x32_bf16 v[32:35], a[36:39], a[4:7], v[32:35]
    ds_read_b64_tr_b16 a[198:199], v23 offset:37888
    v_lshl_add_u32 v26, v45, 2, v26
    v_mul_f32 v113, abs(v113), v113
    v_cvt_pk_bf16_f32 v36, v112, v113
    v_pk_max_i16 v36, v36, 0
    v_mfma_f32_32x32x16_bf16 v[64:79], a[8:11], v[132:135], v[64:79]
    ds_read_b64_tr_b16 a[4:5], v19 offset:20480
    ds_read_b64_tr_b16 a[6:7], v19 offset:20992
    ds_read_b64_tr_b16 a[200:201], v22 offset:38912
    s_and_b32 s40, s2, 7
    v_mul_f32 v114, v28, v114
    v_mul_f32 v115, v28, v115
    v_mul_f32 v114, abs(v114), v114
    v_mfma_f32_16x16x32_bf16 v[32:35], a[32:35], a[8:11], v[32:35]
    ds_read_b64_tr_b16 a[202:203], v22 offset:39936
    s_lshl_b32 s40, s40, 8
    v_mul_f32 v115, abs(v115), v115
    v_cvt_pk_bf16_f32 v37, v114, v115
    v_pk_max_i16 v37, v37, 0
    v_mfma_f32_32x32x16_bf16 v[80:95], a[12:15], v[132:135], v[80:95]
    ds_read_b64_tr_b16 a[8:9], v18 offset:22528
    ds_read_b64_tr_b16 a[10:11], v18 offset:23040
    ds_read_b64_tr_b16 a[204:205], v23 offset:38912
    v_add_u32 v26, s40, v26
    v_mul_f32 v116, v28, v116
    v_mul_f32 v117, v28, v117
    v_mul_f32 v116, abs(v116), v116
    v_mfma_f32_16x16x32_bf16 v[32:35], a[36:39], a[12:15], v[32:35]
    ds_read_b64_tr_b16 a[206:207], v23 offset:39936
    v_mul_f32 v117, abs(v117), v117
    v_cvt_pk_bf16_f32 v38, v116, v117
    v_pk_max_i16 v38, v38, 0
    s_waitcnt lgkmcnt(14)
    v_mfma_f32_32x32x16_bf16 v[64:79], a[16:19], v[136:139], v[64:79]
    ds_read_b64_tr_b16 a[12:13], v19 offset:22528
    ds_read_b64_tr_b16 a[14:15], v19 offset:23040
    v_mul_f32 v118, v28, v118
    v_mul_f32 v119, v28, v119
    v_mul_f32 v118, abs(v118), v118
    v_mfma_f32_32x32x16_bf16 v[80:95], a[20:23], v[136:139], v[80:95]
    ds_read_b64_tr_b16 a[16:17], v20 offset:20480
    ds_read_b64_tr_b16 a[18:19], v20 offset:20992
    s_waitcnt lgkmcnt(4)
    s_add_u32 m0, s39, 36864
    s_add_u32 s49, s57, 0
    buffer_load_dwordx4 v10, s[16:19], s49 offen offset:0 lds
    v_mfma_f32_32x32x16_bf16 v[64:79], a[24:27], v[140:143], v[64:79]
    ds_read_b64_tr_b16 a[20:21], v21 offset:20480
    ds_read_b64_tr_b16 a[22:23], v21 offset:20992
    buffer_load_dwordx4 v11, s[16:19], s49 offen offset:1024 lds
    v_mul_f32 v119, abs(v119), v119
    v_cvt_pk_bf16_f32 v39, v118, v119
    v_pk_max_i16 v39, v39, 0
    v_mfma_f32_32x32x16_bf16 v[80:95], a[28:31], v[140:143], v[80:95]
    ds_read_b64_tr_b16 a[24:25], v20 offset:22528
    ds_read_b64_tr_b16 a[26:27], v20 offset:23040
    buffer_store_dwordx4 v[36:39], v1, s[24:27], s52 offen offset:0 sc1
    s_waitcnt lgkmcnt(6)
    v_mfma_f32_32x32x16_bf16 v[64:79], a[0:3], v[144:147], v[64:79]
    ds_read_b64_tr_b16 a[28:29], v21 offset:22528
    ds_read_b64_tr_b16 a[30:31], v21 offset:23040
    buffer_load_dwordx4 v12, s[16:19], s49 offen offset:2048 lds
    v_mul_f32 v120, v28, v120
    v_mul_f32 v121, v28, v121
    v_mul_f32 v120, abs(v120), v120
    v_mfma_f32_32x32x16_bf16 v[80:95], a[4:7], v[144:147], v[80:95]
    s_barrier
    ds_read_b64_tr_b16 a[0:1], v14 offset:32768
    ds_read_b64_tr_b16 a[2:3], v14 offset:33280
    v_mul_f32 v121, abs(v121), v121
    v_cvt_pk_bf16_f32 v40, v120, v121
    v_pk_max_i16 v40, v40, 0
    v_mfma_f32_32x32x16_bf16 v[64:79], a[8:11], v[148:151], v[64:79]
    ds_read_b64_tr_b16 a[4:5], v15 offset:32768
    ds_read_b64_tr_b16 a[6:7], v15 offset:33280
    s_waitcnt vmcnt(13)
    ds_read_b64_tr_b16 a[208:209], v22 offset:0
    buffer_load_dwordx4 v13, s[16:19], s49 offen offset:3072 lds
    v_mfma_f32_32x32x16_bf16 v[80:95], a[12:15], v[148:151], v[80:95]
    ds_read_b64_tr_b16 a[8:9], v14 offset:34816
    ds_read_b64_tr_b16 a[10:11], v14 offset:35328
    ds_read_b64_tr_b16 a[210:211], v22 offset:1024
    v_mul_f32 v122, v28, v122
    v_mul_f32 v123, v28, v123
    v_mul_f32 v122, abs(v122), v122
    s_waitcnt lgkmcnt(8)
    v_mfma_f32_32x32x16_bf16 v[64:79], a[16:19], v[152:155], v[64:79]
    ds_read_b64_tr_b16 a[12:13], v15 offset:34816
    ds_read_b64_tr_b16 a[14:15], v15 offset:35328
    buffer_load_dword v25, v26, s[24:27], 0 offen sc1
    v_mul_f32 v123, abs(v123), v123
    v_cvt_pk_bf16_f32 v41, v122, v123
    v_pk_max_i16 v41, v41, 0
    v_mfma_f32_32x32x16_bf16 v[80:95], a[20:23], v[152:155], v[80:95]
    ds_read_b64_tr_b16 a[16:17], v16 offset:32768
    ds_read_b64_tr_b16 a[18:19], v16 offset:33280
    ds_read_b64_tr_b16 a[212:213], v23 offset:0
    ds_read_b64_tr_b16 a[214:215], v23 offset:1024
    v_mul_f32 v124, v28, v124
    v_mfma_f32_32x32x16_bf16 v[64:79], a[24:27], v[156:159], v[64:79]
    ds_read_b64_tr_b16 a[20:21], v17 offset:32768
    ds_read_b64_tr_b16 a[22:23], v17 offset:33280
    ds_read_b64_tr_b16 a[216:217], v22 offset:2048
    v_mul_f32 v125, v28, v125
    v_mul_f32 v124, abs(v124), v124
    v_mfma_f32_32x32x16_bf16 v[80:95], a[28:31], v[156:159], v[80:95]
    ds_read_b64_tr_b16 a[24:25], v16 offset:34816
    ds_read_b64_tr_b16 a[26:27], v16 offset:35328
    ds_read_b64_tr_b16 a[218:219], v22 offset:3072
    v_mul_f32 v125, abs(v125), v125
    v_cvt_pk_bf16_f32 v42, v124, v125
    s_waitcnt lgkmcnt(10)
    v_mfma_f32_32x32x16_bf16 v[64:79], a[0:3], v[160:163], v[64:79]
    ds_read_b64_tr_b16 a[28:29], v17 offset:34816
    ds_read_b64_tr_b16 a[30:31], v17 offset:35328
    ds_read_b64_tr_b16 a[220:221], v23 offset:2048
    v_pk_max_i16 v42, v42, 0
    v_mul_f32 v126, v28, v126
    v_mfma_f32_16x16x32_bf16 v[32:35], a[32:35], a[0:3], v[32:35]
    ds_read_b64_tr_b16 a[222:223], v23 offset:3072
    v_mul_f32 v127, v28, v127
    v_mul_f32 v126, abs(v126), v126
    v_mfma_f32_32x32x16_bf16 v[80:95], a[4:7], v[160:163], v[80:95]
    ds_read_b64_tr_b16 a[0:1], v18 offset:32768
    ds_read_b64_tr_b16 a[2:3], v18 offset:33280
    v_mul_f32 v127, abs(v127), v127
    v_cvt_pk_bf16_f32 v43, v126, v127
    v_pk_max_i16 v43, v43, 0
    v_mfma_f32_16x16x32_bf16 v[32:35], a[36:39], a[4:7], v[32:35]
    s_waitcnt lgkmcnt(2)
    s_add_u32 m0, s39, 0
    s_add_u32 s49, s57, 32768
    buffer_load_dwordx4 v10, s[16:19], s49 offen offset:0 lds
    v_mfma_f32_32x32x16_bf16 v[64:79], a[8:11], v[164:167], v[64:79]
    ds_read_b64_tr_b16 a[4:5], v19 offset:32768
    ds_read_b64_tr_b16 a[6:7], v19 offset:33280
    s_waitcnt vmcnt(11)
    ds_read_b64_tr_b16 a[224:225], v22 offset:4096
    buffer_store_dwordx4 v[40:43], v1, s[24:27], s52 offen offset:1024 sc1
    v_mfma_f32_16x16x32_bf16 v[32:35], a[32:35], a[8:11], v[32:35]
    ds_read_b64_tr_b16 a[226:227], v22 offset:5120
    buffer_load_dwordx4 v11, s[16:19], s49 offen offset:1024 lds
    v_mfma_f32_32x32x16_bf16 v[80:95], a[12:15], v[164:167], v[80:95]
    ds_read_b64_tr_b16 a[8:9], v18 offset:34816
    ds_read_b64_tr_b16 a[10:11], v18 offset:35328
    ds_read_b64_tr_b16 a[228:229], v23 offset:4096
    v_accvgpr_read_b32 v96, a112
    v_accvgpr_read_b32 v97, a113
    v_mul_f32 v96, v28, v96
    v_mfma_f32_16x16x32_bf16 v[32:35], a[36:39], a[12:15], v[32:35]
    ds_read_b64_tr_b16 a[230:231], v23 offset:5120
    v_mul_f32 v97, v28, v97
    v_mul_f32 v96, abs(v96), v96
    v_mfma_f32_32x32x16_bf16 v[64:79], a[16:19], v[168:171], v[64:79]
    ds_read_b64_tr_b16 a[12:13], v19 offset:34816
    ds_read_b64_tr_b16 a[14:15], v19 offset:35328
    ds_read_b64_tr_b16 a[232:233], v22 offset:6144
    buffer_load_dwordx4 v12, s[16:19], s49 offen offset:2048 lds
    v_mfma_f32_32x32x16_bf16 v[80:95], a[20:23], v[168:171], v[80:95]
    ds_read_b64_tr_b16 a[16:17], v20 offset:32768
    ds_read_b64_tr_b16 a[18:19], v20 offset:33280
    ds_read_b64_tr_b16 a[234:235], v22 offset:7168
    buffer_load_dwordx4 v13, s[16:19], s49 offen offset:3072 lds
    v_mfma_f32_32x32x16_bf16 v[64:79], a[24:27], v[172:175], v[64:79]
    ds_read_b64_tr_b16 a[20:21], v21 offset:32768
    ds_read_b64_tr_b16 a[22:23], v21 offset:33280
    ds_read_b64_tr_b16 a[236:237], v23 offset:6144
    v_mul_f32 v97, abs(v97), v97
    v_cvt_pk_bf16_f32 v36, v96, v97
    v_mfma_f32_32x32x16_bf16 v[80:95], a[28:31], v[172:175], v[80:95]
    ds_read_b64_tr_b16 a[24:25], v20 offset:34816
    ds_read_b64_tr_b16 a[26:27], v20 offset:35328
    ds_read_b64_tr_b16 a[238:239], v23 offset:7168
    v_pk_max_i16 v36, v36, 0
    v_accvgpr_read_b32 v98, a114
    s_waitcnt lgkmcnt(10)
    v_mfma_f32_32x32x16_bf16 v[64:79], a[0:3], v[176:179], v[64:79]
    ds_read_b64_tr_b16 a[28:29], v21 offset:34816
    ds_read_b64_tr_b16 a[30:31], v21 offset:35328
    v_accvgpr_read_b32 v99, a115
    v_mul_f32 v98, v28, v98
    v_mul_f32 v99, v28, v99
    v_mfma_f32_32x32x16_bf16 v[80:95], a[4:7], v[176:179], v[80:95]
    s_barrier
    ds_read_b64_tr_b16 a[0:1], v14 offset:24576
    ds_read_b64_tr_b16 a[2:3], v14 offset:25088
    v_mul_f32 v98, abs(v98), v98
    v_mul_f32 v99, abs(v99), v99
    v_mfma_f32_32x32x16_bf16 v[64:79], a[8:11], v[180:183], v[64:79]
    ds_read_b64_tr_b16 a[4:5], v15 offset:24576
    ds_read_b64_tr_b16 a[6:7], v15 offset:25088
    v_cvt_pk_bf16_f32 v37, v98, v99
    v_pk_max_i16 v37, v37, 0
    v_accvgpr_read_b32 v100, a116
    v_mfma_f32_32x32x16_bf16 v[80:95], a[12:15], v[180:183], v[80:95]
    ds_read_b64_tr_b16 a[8:9], v14 offset:26624
    ds_read_b64_tr_b16 a[10:11], v14 offset:27136
    s_waitcnt vmcnt(11)
    ds_read_b64_tr_b16 a[240:241], v22 offset:8192
    v_accvgpr_read_b32 v101, a117
    s_waitcnt lgkmcnt(7)
    v_mfma_f32_32x32x16_bf16 v[64:79], a[16:19], v[184:187], v[64:79]
    ds_read_b64_tr_b16 a[12:13], v15 offset:26624
    ds_read_b64_tr_b16 a[14:15], v15 offset:27136
    ds_read_b64_tr_b16 a[242:243], v22 offset:9216
    v_mul_f32 v100, v28, v100
    v_mul_f32 v101, v28, v101
    v_mfma_f32_32x32x16_bf16 v[80:95], a[20:23], v[184:187], v[80:95]
    ds_read_b64_tr_b16 a[16:17], v16 offset:24576
    ds_read_b64_tr_b16 a[18:19], v16 offset:25088
    ds_read_b64_tr_b16 a[244:245], v23 offset:8192
    v_mul_f32 v100, abs(v100), v100
    v_mul_f32 v101, abs(v101), v101
    v_mfma_f32_32x32x16_bf16 v[64:79], a[24:27], v[188:191], v[64:79]
    ds_read_b64_tr_b16 a[20:21], v17 offset:24576
    ds_read_b64_tr_b16 a[22:23], v17 offset:25088
    ds_read_b64_tr_b16 a[246:247], v23 offset:9216
    v_cvt_pk_bf16_f32 v38, v100, v101
    v_pk_max_i16 v38, v38, 0
    v_mfma_f32_32x32x16_bf16 v[80:95], a[28:31], v[188:191], v[80:95]
    ds_read_b64_tr_b16 a[24:25], v16 offset:26624
    ds_read_b64_tr_b16 a[26:27], v16 offset:27136
    ds_read_b64_tr_b16 a[248:249], v22 offset:10240
    v_accvgpr_read_b32 v102, a118
    v_accvgpr_read_b32 v103, a119
    s_waitcnt lgkmcnt(10)
    v_mfma_f32_32x32x16_bf16 v[64:79], a[0:3], v[192:195], v[64:79]
    ds_read_b64_tr_b16 a[28:29], v17 offset:26624
    ds_read_b64_tr_b16 a[30:31], v17 offset:27136
    s_waitcnt vmcnt(5)
    v_cmp_gt_u32 vcc, 1, v25
    s_cbranch_vccnz Lretry_6e
Lok_5:
    v_mul_f32 v102, v28, v102
    v_mfma_f32_16x16x32_bf16 v[32:35], a[32:35], a[0:3], v[32:35]
    ds_read_b64_tr_b16 a[250:251], v22 offset:11264
    s_add_u32 m0, s39, 16384
    s_nop 0
    buffer_load_dwordx4 v1, s[24:27], s5 offen offset:0 sc1 lds
    v_mfma_f32_32x32x16_bf16 v[80:95], a[4:7], v[192:195], v[80:95]
    ds_read_b64_tr_b16 a[0:1], v18 offset:24576
    ds_read_b64_tr_b16 a[2:3], v18 offset:25088
    ds_read_b64_tr_b16 a[252:253], v23 offset:10240
    buffer_load_dwordx4 v1, s[24:27], s5 offen offset:1024 sc1 lds
    v_mfma_f32_16x16x32_bf16 v[32:35], a[36:39], a[4:7], v[32:35]
    ds_read_b64_tr_b16 a[254:255], v23 offset:11264
    v_mul_f32 v103, v28, v103
    v_mul_f32 v102, abs(v102), v102
    v_mfma_f32_32x32x16_bf16 v[64:79], a[8:11], v[196:199], v[64:79]
    ds_read_b64_tr_b16 a[4:5], v19 offset:24576
    ds_read_b64_tr_b16 a[6:7], v19 offset:25088
    v_mul_f32 v103, abs(v103), v103
    v_cvt_pk_bf16_f32 v39, v102, v103
    v_pk_max_i16 v39, v39, 0
    v_mfma_f32_16x16x32_bf16 v[32:35], a[32:35], a[8:11], v[32:35]
    buffer_store_dwordx4 v[36:39], v1, s[24:27], s52 offen offset:2048 sc1
    v_mfma_f32_32x32x16_bf16 v[80:95], a[12:15], v[196:199], v[80:95]
    ds_read_b64_tr_b16 a[8:9], v18 offset:26624
    ds_read_b64_tr_b16 a[10:11], v18 offset:27136
    buffer_load_dwordx4 v1, s[24:27], s5 offen offset:2048 sc1 lds
    v_accvgpr_read_b32 v104, a120
    v_accvgpr_read_b32 v105, a121
    v_mul_f32 v104, v28, v104
    v_mfma_f32_16x16x32_bf16 v[32:35], a[36:39], a[12:15], v[32:35]
    v_mul_f32 v105, v28, v105
    v_mul_f32 v104, abs(v104), v104
    v_mul_f32 v105, abs(v105), v105
    s_waitcnt lgkmcnt(9)
    v_mfma_f32_32x32x16_bf16 v[64:79], a[16:19], v[200:203], v[64:79]
    ds_read_b64_tr_b16 a[12:13], v19 offset:26624
    ds_read_b64_tr_b16 a[14:15], v19 offset:27136
    buffer_load_dwordx4 v1, s[24:27], s5 offen offset:3072 sc1 lds
    v_cvt_pk_bf16_f32 v40, v104, v105
    v_pk_max_i16 v40, v40, 0
    v_mfma_f32_32x32x16_bf16 v[80:95], a[20:23], v[200:203], v[80:95]
    ds_read_b64_tr_b16 a[16:17], v20 offset:24576
    ds_read_b64_tr_b16 a[18:19], v20 offset:25088
    v_accvgpr_read_b32 v106, a122
    v_accvgpr_read_b32 v107, a123
    v_mul_f32 v106, v28, v106
    v_mfma_f32_32x32x16_bf16 v[64:79], a[24:27], v[204:207], v[64:79]
    ds_read_b64_tr_b16 a[20:21], v21 offset:24576
    ds_read_b64_tr_b16 a[22:23], v21 offset:25088
    buffer_load_dwordx4 a[64:67], v1, s[24:27], s9 offen offset:0 sc1
    v_mul_f32 v107, v28, v107
    v_mul_f32 v106, abs(v106), v106
    v_mfma_f32_32x32x16_bf16 v[80:95], a[28:31], v[204:207], v[80:95]
    ds_read_b64_tr_b16 a[24:25], v20 offset:26624
    ds_read_b64_tr_b16 a[26:27], v20 offset:27136
    v_mul_f32 v107, abs(v107), v107
    v_cvt_pk_bf16_f32 v41, v106, v107
    s_waitcnt lgkmcnt(6)
    v_mfma_f32_32x32x16_bf16 v[64:79], a[0:3], v[208:211], v[64:79]
    ds_read_b64_tr_b16 a[28:29], v21 offset:26624
    ds_read_b64_tr_b16 a[30:31], v21 offset:27136
    buffer_load_dwordx4 a[68:71], v1, s[24:27], s9 offen offset:1024 sc1
    v_pk_max_i16 v41, v41, 0
    v_accvgpr_read_b32 v108, a124
    v_mfma_f32_32x32x16_bf16 v[80:95], a[4:7], v[208:211], v[80:95]
    s_barrier
    ds_read_b64_tr_b16 a[0:1], v14 offset:28672
    ds_read_b64_tr_b16 a[2:3], v14 offset:29184
    s_add_u32 m0, s39, 20480
    v_accvgpr_read_b32 v109, a125
    v_mul_f32 v108, v28, v108
    v_mfma_f32_32x32x16_bf16 v[64:79], a[8:11], v[212:215], v[64:79]
    ds_read_b64_tr_b16 a[4:5], v15 offset:28672
    ds_read_b64_tr_b16 a[6:7], v15 offset:29184
    buffer_load_dwordx4 v9, s[24:27], s5 offen offset:0 sc1 lds
    v_mul_f32 v109, v28, v109
    v_mul_f32 v108, abs(v108), v108
    v_mfma_f32_32x32x16_bf16 v[80:95], a[12:15], v[212:215], v[80:95]
    ds_read_b64_tr_b16 a[8:9], v14 offset:30720
    ds_read_b64_tr_b16 a[10:11], v14 offset:31232
    v_mul_f32 v109, abs(v109), v109
    v_cvt_pk_bf16_f32 v42, v108, v109
    s_waitcnt lgkmcnt(6)
    v_mfma_f32_32x32x16_bf16 v[64:79], a[16:19], v[216:219], v[64:79]
    ds_read_b64_tr_b16 a[12:13], v15 offset:30720
    ds_read_b64_tr_b16 a[14:15], v15 offset:31232
    buffer_load_dwordx4 v9, s[24:27], s5 offen offset:1024 sc1 lds
    v_pk_max_i16 v42, v42, 0
    v_accvgpr_read_b32 v110, a126
    v_mfma_f32_32x32x16_bf16 v[80:95], a[20:23], v[216:219], v[80:95]
    ds_read_b64_tr_b16 a[16:17], v16 offset:28672
    ds_read_b64_tr_b16 a[18:19], v16 offset:29184
    v_accvgpr_read_b32 v111, a127
    v_mul_f32 v110, v28, v110
    v_mul_f32 v111, v28, v111
    v_mfma_f32_32x32x16_bf16 v[64:79], a[24:27], v[220:223], v[64:79]
    ds_read_b64_tr_b16 a[20:21], v17 offset:28672
    ds_read_b64_tr_b16 a[22:23], v17 offset:29184
    buffer_load_dwordx4 v9, s[24:27], s5 offen offset:2048 sc1 lds
    v_mul_f32 v110, abs(v110), v110
    v_mul_f32 v111, abs(v111), v111
    v_mfma_f32_32x32x16_bf16 v[80:95], a[28:31], v[220:223], v[80:95]
    ds_read_b64_tr_b16 a[24:25], v16 offset:30720
    ds_read_b64_tr_b16 a[26:27], v16 offset:31232
    v_cvt_pk_bf16_f32 v43, v110, v111
    v_pk_max_i16 v43, v43, 0
    s_waitcnt lgkmcnt(6)
    v_mfma_f32_32x32x16_bf16 v[64:79], a[0:3], v[224:227], v[64:79]
    ds_read_b64_tr_b16 a[28:29], v17 offset:30720
    ds_read_b64_tr_b16 a[30:31], v17 offset:31232
    buffer_load_dwordx4 v9, s[24:27], s5 offen offset:3072 sc1 lds
    buffer_store_dwordx4 v[40:43], v1, s[24:27], s52 offen offset:3072 sc1
    v_mfma_f32_16x16x32_bf16 v[32:35], a[32:35], a[0:3], v[32:35]
    s_add_u32 m0, s39, 4096
    v_mfma_f32_32x32x16_bf16 v[80:95], a[4:7], v[224:227], v[80:95]
    ds_read_b64_tr_b16 a[0:1], v18 offset:28672
    ds_read_b64_tr_b16 a[2:3], v18 offset:29184
    s_add_u32 s49, s57, 131072
    v_mfma_f32_16x16x32_bf16 v[32:35], a[36:39], a[4:7], v[32:35]
    buffer_load_dwordx4 v10, s[16:19], s49 offen offset:0 lds
    v_mfma_f32_32x32x16_bf16 v[64:79], a[8:11], v[228:231], v[64:79]
    ds_read_b64_tr_b16 a[4:5], v19 offset:28672
    ds_read_b64_tr_b16 a[6:7], v19 offset:29184
    v_mfma_f32_16x16x32_bf16 v[32:35], a[32:35], a[8:11], v[32:35]
    v_mfma_f32_32x32x16_bf16 v[80:95], a[12:15], v[228:231], v[80:95]
    ds_read_b64_tr_b16 a[8:9], v18 offset:30720
    ds_read_b64_tr_b16 a[10:11], v18 offset:31232
    buffer_load_dwordx4 v11, s[16:19], s49 offen offset:1024 lds
    v_mfma_f32_16x16x32_bf16 v[32:35], a[36:39], a[12:15], v[32:35]
    s_waitcnt lgkmcnt(6)
    v_mfma_f32_32x32x16_bf16 v[64:79], a[16:19], v[232:235], v[64:79]
    ds_read_b64_tr_b16 a[12:13], v19 offset:30720
    ds_read_b64_tr_b16 a[14:15], v19 offset:31232
    buffer_load_dwordx4 v12, s[16:19], s49 offen offset:2048 lds
    v_mfma_f32_32x32x16_bf16 v[80:95], a[20:23], v[232:235], v[80:95]
    ds_read_b64_tr_b16 a[16:17], v20 offset:28672
    ds_read_b64_tr_b16 a[18:19], v20 offset:29184
    v_and_b32 v33, s44, v32
    v_sub_f32 v33, v32, v33
    v_mfma_f32_32x32x16_bf16 v[64:79], a[24:27], v[236:239], v[64:79]
    ds_read_b64_tr_b16 a[20:21], v21 offset:28672
    ds_read_b64_tr_b16 a[22:23], v21 offset:29184
    v_and_b32 v34, s44, v33
    v_sub_f32 v35, v33, v34
    buffer_load_dwordx4 v13, s[16:19], s49 offen offset:3072 lds
    v_mfma_f32_32x32x16_bf16 v[80:95], a[28:31], v[236:239], v[80:95]
    ds_read_b64_tr_b16 a[24:25], v20 offset:30720
    ds_read_b64_tr_b16 a[26:27], v20 offset:31232
    v_perm_b32 v34, v33, v32, s67
    v_perm_b32 v35, v47, v35, s67
    s_add_u32 m0, s39, 8192
    s_waitcnt lgkmcnt(6)
    v_mfma_f32_32x32x16_bf16 v[64:79], a[0:3], v[240:243], v[64:79]
    ds_read_b64_tr_b16 a[28:29], v21 offset:30720
    ds_read_b64_tr_b16 a[30:31], v21 offset:31232
    ds_write_b64 v31, v[34:35] offset:13824
    s_add_u32 s49, s57, 163840
    v_mfma_f32_32x32x16_bf16 v[80:95], a[4:7], v[240:243], v[80:95]
    s_waitcnt lgkmcnt(0)
    s_barrier
    ds_read_b64 a[44:45], v30 offset:13824
    buffer_load_dwordx4 v10, s[16:19], s49 offen offset:0 lds
    v_mfma_f32_32x32x16_bf16 v[64:79], a[8:11], v[244:247], v[64:79]
    ds_read_b64 a[46:47], v30 offset:54784
    v_mfma_f32_32x32x16_bf16 v[80:95], a[12:15], v[244:247], v[80:95]
    ds_read_b64 a[48:49], v30 offset:14080
    v_mfma_f32_32x32x16_bf16 v[64:79], a[16:19], v[248:251], v[64:79]
    ds_read_b64 a[50:51], v30 offset:55040
    buffer_load_dwordx4 v11, s[16:19], s49 offen offset:1024 lds
    v_mfma_f32_32x32x16_bf16 v[80:95], a[20:23], v[248:251], v[80:95]
    v_mfma_f32_32x32x16_bf16 v[64:79], a[24:27], v[252:255], v[64:79]
    buffer_load_dwordx4 v12, s[16:19], s49 offen offset:2048 lds
    v_mfma_f32_32x32x16_bf16 v[80:95], a[28:31], v[252:255], v[80:95]
    s_waitcnt lgkmcnt(2)
    v_mfma_f32_32x32x16_bf16 v[64:79], a[44:47], a[40:43], v[64:79]
    buffer_load_dwordx4 v13, s[16:19], s49 offen offset:3072 lds
    s_waitcnt lgkmcnt(0)
    v_mfma_f32_32x32x16_bf16 v[80:95], a[48:51], a[40:43], v[80:95]
    s_nop 8
    v_mul_f32 v64, v28, v64
    v_mul_f32 v65, v28, v65
    v_mul_f32 v64, abs(v64), v64
    v_mul_f32 v65, abs(v65), v65
    v_cvt_pk_bf16_f32 v36, v64, v65
    v_pk_max_i16 v36, v36, 0
    v_mul_f32 v66, v28, v66
    v_mul_f32 v67, v28, v67
    v_mul_f32 v66, abs(v66), v66
    v_mul_f32 v67, abs(v67), v67
    v_cvt_pk_bf16_f32 v37, v66, v67
    v_pk_max_i16 v37, v37, 0
    v_mul_f32 v68, v28, v68
    v_mul_f32 v69, v28, v69
    v_mul_f32 v68, abs(v68), v68
    v_mul_f32 v69, abs(v69), v69
    v_cvt_pk_bf16_f32 v38, v68, v69
    v_pk_max_i16 v38, v38, 0
    v_mul_f32 v70, v28, v70
    v_mul_f32 v71, v28, v71
    v_mul_f32 v70, abs(v70), v70
    v_mul_f32 v71, abs(v71), v71
    v_cvt_pk_bf16_f32 v39, v70, v71
    v_pk_max_i16 v39, v39, 0
    buffer_store_dwordx4 v[36:39], v1, s[24:27], s54 offen offset:0 sc1
    v_mul_f32 v72, v28, v72
    v_mul_f32 v73, v28, v73
    v_mul_f32 v72, abs(v72), v72
    v_mul_f32 v73, abs(v73), v73
    v_cvt_pk_bf16_f32 v40, v72, v73
    v_pk_max_i16 v40, v40, 0
    v_mul_f32 v74, v28, v74
    v_mul_f32 v75, v28, v75
    v_mul_f32 v74, abs(v74), v74
    v_mul_f32 v75, abs(v75), v75
    v_cvt_pk_bf16_f32 v41, v74, v75
    v_pk_max_i16 v41, v41, 0
    v_mul_f32 v76, v28, v76
    v_mul_f32 v77, v28, v77
    v_mul_f32 v76, abs(v76), v76
    v_mul_f32 v77, abs(v77), v77
    v_cvt_pk_bf16_f32 v42, v76, v77
    v_pk_max_i16 v42, v42, 0
    v_mul_f32 v78, v28, v78
    v_mul_f32 v79, v28, v79
    v_mul_f32 v78, abs(v78), v78
    v_mul_f32 v79, abs(v79), v79
    v_cvt_pk_bf16_f32 v43, v78, v79
    v_pk_max_i16 v43, v43, 0
    buffer_store_dwordx4 v[40:43], v1, s[24:27], s54 offen offset:1024 sc1
    s_waitcnt vmcnt(11)
    s_barrier
    s_waitcnt vmcnt(10)
    v_mov_b32 v25, 1
    s_mov_b64 exec, 1
    buffer_store_dword v25, off, s[24:27], s64 sc1
    s_mov_b64 exec, -1
    ds_read_b128 a[72:75], v48 offset:0
    v_mul_f32 v80, v28, v80
    ds_read_b128 a[104:107], v50 offset:0
    v_mul_f32 v81, v28, v81
    v_mul_f32 v80, abs(v80), v80
    ds_read_b128 a[100:103], v49 offset:41984
    v_mul_f32 v81, abs(v81), v81
    v_cvt_pk_bf16_f32 v36, v80, v81
    ds_read_b128 a[96:99], v49 offset:40960
    v_pk_max_i16 v36, v36, 0
    ds_read_b128 a[92:95], v48 offset:41984
    v_mul_f32 v82, v28, v82
    v_mul_f32 v83, v28, v83
    ds_read_b128 a[88:91], v48 offset:40960
    v_mul_f32 v82, abs(v82), v82
    v_mul_f32 v83, abs(v83), v83
    ds_read_b128 a[84:87], v49 offset:1024
    v_cvt_pk_bf16_f32 v37, v82, v83
    ds_read_b128 a[80:83], v49 offset:0
    v_pk_max_i16 v37, v37, 0
    v_mul_f32 v84, v28, v84
    ds_read_b128 a[76:79], v48 offset:1024
    v_mul_f32 v85, v28, v85
    v_mul_f32 v84, abs(v84), v84
    ds_read_b128 a[108:111], v50 offset:1024
    v_mul_f32 v85, abs(v85), v85
    ds_read_b128 v[160:163], v53 offset:4096
    v_cvt_pk_bf16_f32 v38, v84, v85
    v_pk_max_i16 v38, v38, 0
    ds_read_b128 v[200:203], v53 offset:4352
    v_mul_f32 v86, v28, v86
    v_mul_f32 v87, v28, v87
    ds_read_b128 v[128:131], v51 offset:4096
    v_mul_f32 v86, abs(v86), v86
    ds_read_b128 v[168:171], v51 offset:4352
    v_mul_f32 v87, abs(v87), v87
    v_cvt_pk_bf16_f32 v39, v86, v87
    ds_read_b128 v[156:159], v52 offset:46080
    v_pk_max_i16 v39, v39, 0
    buffer_store_dwordx4 v[36:39], v1, s[24:27], s55 offen offset:0 sc1
    ds_read_b128 v[196:199], v52 offset:46336
    v_mul_f32 v88, v28, v88
    ds_read_b128 v[152:155], v52 offset:45056
    v_mul_f32 v89, v28, v89
    v_mul_f32 v88, abs(v88), v88
    ds_read_b128 v[192:195], v52 offset:45312
    v_mul_f32 v89, abs(v89), v89
    v_cvt_pk_bf16_f32 v40, v88, v89
    ds_read_b128 v[148:151], v51 offset:46080
    v_pk_max_i16 v40, v40, 0
    ds_read_b128 v[188:191], v51 offset:46336
    v_mul_f32 v90, v28, v90
    v_mul_f32 v91, v28, v91
    ds_read_b128 v[144:147], v51 offset:45056
    v_mul_f32 v90, abs(v90), v90
    v_mul_f32 v91, abs(v91), v91
    ds_read_b128 v[184:187], v51 offset:45312
    v_cvt_pk_bf16_f32 v41, v90, v91
    ds_read_b128 v[140:143], v52 offset:5120
    v_pk_max_i16 v41, v41, 0
    v_mul_f32 v92, v28, v92
    ds_read_b128 v[180:183], v52 offset:5376
    v_mul_f32 v93, v28, v93
    v_mul_f32 v92, abs(v92), v92
    ds_read_b128 v[136:139], v52 offset:4096
    v_mul_f32 v93, abs(v93), v93
    ds_read_b128 v[176:179], v52 offset:4352
    v_cvt_pk_bf16_f32 v42, v92, v93
    v_pk_max_i16 v42, v42, 0
    ds_read_b128 v[132:135], v51 offset:5120
    v_mul_f32 v94, v28, v94
    v_mul_f32 v95, v28, v95
    ds_read_b128 v[172:175], v51 offset:5376
    v_mul_f32 v94, abs(v94), v94
    ds_read_b128 v[164:167], v53 offset:5120
    v_mul_f32 v95, abs(v95), v95
    v_cvt_pk_bf16_f32 v43, v94, v95
    ds_read_b128 v[204:207], v53 offset:5376
    v_pk_max_i16 v43, v43, 0
    buffer_store_dwordx4 v[40:43], v1, s[24:27], s55 offen offset:1024 sc1
    v_mov_b32 v4, 0xf149f2ca
    v_mov_b32 v5, 0xd800000
    v_mov_b32 v6, 0x71800000
    s_waitcnt lgkmcnt(15)
    v_mfma_f32_32x32x16_bf16 v[208:223], a[72:75], a[64:67], 0
    v_mfma_f32_32x32x16_bf16 v[224:239], a[104:107], a[64:67], 0
    v_mfma_f32_32x32x16_bf16 v[240:255], a[100:103], a[64:67], 0
    s_add_u32 m0, s39, 32768
    s_add_u32 s49, s57, 262144
    buffer_load_dwordx4 v10, s[16:19], s49 offen offset:0 lds
    s_nop 7
    v_cndmask_b32 v224, v208, v224, s[68:69]
    v_cndmask_b32 v225, v209, v225, s[70:71]
    v_cndmask_b32 v226, v210, v226, s[72:73]
    v_cndmask_b32 v227, v211, v227, s[74:75]
    v_cndmask_b32 v228, v212, v228, s[76:77]
    v_cndmask_b32 v229, v213, v229, s[78:79]
    v_cndmask_b32 v230, v214, v230, s[80:81]
    v_cndmask_b32 v231, v215, v231, s[82:83]
    v_cndmask_b32 v232, v216, v232, s[84:85]
    v_cndmask_b32 v233, v217, v233, s[86:87]
    v_cndmask_b32 v234, v218, v234, s[88:89]
    v_cndmask_b32 v235, v219, v235, s[90:91]
    v_cndmask_b32 v236, v220, v236, s[92:93]
    v_cndmask_b32 v237, v221, v237, s[94:95]
    v_cndmask_b32 v238, v222, v238, s[96:97]
    v_cndmask_b32 v239, v223, v239, s[98:99]
    buffer_load_dwordx4 v11, s[16:19], s49 offen offset:1024 lds
    v_exp_f32 v224, v224
    v_exp_f32 v225, v225
    v_exp_f32 v226, v226
    v_exp_f32 v227, v227
    v_cvt_pk_bf16_f32 v112, v224, v225
    v_exp_f32 v228, v228
    v_exp_f32 v229, v229
    v_cvt_pk_bf16_f32 v113, v226, v227
    v_exp_f32 v230, v230
    v_exp_f32 v231, v231
    buffer_load_dwordx4 v12, s[16:19], s49 offen offset:2048 lds
    v_cvt_pk_bf16_f32 v114, v228, v229
    v_exp_f32 v232, v232
    v_exp_f32 v233, v233
    v_cvt_pk_bf16_f32 v115, v230, v231
    v_exp_f32 v234, v234
    v_exp_f32 v235, v235
    v_cvt_pk_bf16_f32 v116, v232, v233
    v_exp_f32 v236, v236
    v_exp_f32 v237, v237
    v_cvt_pk_bf16_f32 v117, v234, v235
    buffer_load_dwordx4 v13, s[16:19], s49 offen offset:3072 lds
    v_exp_f32 v238, v238
    v_exp_f32 v239, v239
    v_cvt_pk_bf16_f32 v118, v236, v237
    v_cvt_pk_bf16_f32 v119, v238, v239
    v_bfi_b32 v48, v56, 0, v112
    v_and_b32 v112, v56, v112
    v_bfi_b32 v49, v57, 0, v113
    v_and_b32 v113, v57, v113
    v_bfi_b32 v50, v58, 0, v114
    v_and_b32 v114, v58, v114
    v_bfi_b32 v51, v59, 0, v115
    v_and_b32 v115, v59, v115
    v_bfi_b32 v52, v60, 0, v116
    v_and_b32 v116, v60, v116
    v_bfi_b32 v53, v61, 0, v117
    v_and_b32 v117, v61, v117
    v_bfi_b32 v54, v62, 0, v118
    v_and_b32 v118, v62, v118
    v_bfi_b32 v55, v63, 0, v119
    v_and_b32 v119, v63, v119
    s_waitcnt lgkmcnt(0)
    s_barrier
    s_add_u32 m0, s39, 24576
    s_add_u32 s49, s57, 294912
    buffer_load_dwordx4 v10, s[16:19], s49 offen offset:0 lds
    v_mfma_f32_32x32x16_bf16 v[208:223], a[96:99], a[64:67], 0
    v_exp_f32 v240, v240
    v_exp_f32 v241, v241
    v_exp_f32 v242, v242
    v_exp_f32 v243, v243
    v_mfma_f32_32x32x16_bf16 v[80:95], v[160:163], v[112:115], 0
    v_cvt_pk_bf16_f32 v120, v240, v241
    v_exp_f32 v244, v244
    v_exp_f32 v245, v245
    v_cvt_pk_bf16_f32 v121, v242, v243
    v_exp_f32 v246, v246
    buffer_load_dwordx4 v11, s[16:19], s49 offen offset:1024 lds
    v_mfma_f32_32x32x16_bf16 v[80:95], v[200:203], v[116:119], v[80:95]
    v_exp_f32 v247, v247
    v_cvt_pk_bf16_f32 v122, v244, v245
    v_exp_f32 v248, v248
    v_exp_f32 v249, v249
    v_cvt_pk_bf16_f32 v123, v246, v247
    v_mfma_f32_32x32x16_bf16 v[80:95], v[128:131], v[48:51], v[80:95]
    v_exp_f32 v250, v250
    v_exp_f32 v251, v251
    v_cvt_pk_bf16_f32 v124, v248, v249
    v_exp_f32 v252, v252
    v_exp_f32 v253, v253
    buffer_load_dwordx4 v12, s[16:19], s49 offen offset:2048 lds
    v_mfma_f32_32x32x16_bf16 v[80:95], v[168:171], v[52:55], v[80:95]
    v_cvt_pk_bf16_f32 v125, v250, v251
    v_exp_f32 v254, v254
    v_exp_f32 v255, v255
    v_cvt_pk_bf16_f32 v126, v252, v253
    v_cvt_pk_bf16_f32 v127, v254, v255
    s_add_u32 s64, s64, 32768
    s_waitcnt vmcnt(7)
    v_mov_b32 v44, 1
    s_mov_b64 exec, 1
    buffer_store_dword v44, off, s[24:27], s64 sc1
    s_mov_b64 exec, -1
    buffer_load_dwordx4 v13, s[16:19], s49 offen offset:3072 lds
    v_mfma_f32_32x32x16_bf16 v[224:239], a[92:95], a[64:67], 0
    v_exp_f32 v208, v208
    v_exp_f32 v209, v209
    v_exp_f32 v210, v210
    v_exp_f32 v211, v211
    v_cvt_pk_bf16_f32 v112, v208, v209
    v_exp_f32 v212, v212
    v_exp_f32 v213, v213
    v_cvt_pk_bf16_f32 v113, v210, v211
    s_add_u32 m0, s39, 28672
    s_add_u32 s49, s57, 327680
    buffer_load_dwordx4 v10, s[16:19], s49 offen offset:0 lds
    v_mfma_f32_32x32x16_bf16 v[80:95], v[156:159], v[120:123], v[80:95]
    v_exp_f32 v214, v214
    v_exp_f32 v215, v215
    v_cvt_pk_bf16_f32 v114, v212, v213
    v_exp_f32 v216, v216
    v_exp_f32 v217, v217
    v_cvt_pk_bf16_f32 v115, v214, v215
    v_exp_f32 v218, v218
    v_exp_f32 v219, v219
    buffer_load_dwordx4 v11, s[16:19], s49 offen offset:1024 lds
    v_mfma_f32_32x32x16_bf16 v[80:95], v[196:199], v[124:127], v[80:95]
    v_cvt_pk_bf16_f32 v116, v216, v217
    v_exp_f32 v220, v220
    v_exp_f32 v221, v221
    v_cvt_pk_bf16_f32 v117, v218, v219
    v_exp_f32 v222, v222
    v_exp_f32 v223, v223
    v_cvt_pk_bf16_f32 v118, v220, v221
    v_cvt_pk_bf16_f32 v119, v222, v223
    v_mfma_f32_32x32x16_bf16 v[240:255], a[88:91], a[64:67], 0
    v_exp_f32 v224, v224
    v_exp_f32 v225, v225
    v_exp_f32 v226, v226
    v_exp_f32 v227, v227
    v_cvt_pk_bf16_f32 v120, v224, v225
    v_exp_f32 v228, v228
    v_exp_f32 v229, v229
    v_cvt_pk_bf16_f32 v121, v226, v227
    buffer_load_dwordx4 v12, s[16:19], s49 offen offset:2048 lds
    v_mfma_f32_32x32x16_bf16 v[80:95], v[152:155], v[112:115], v[80:95]
    v_exp_f32 v230, v230
    v_exp_f32 v231, v231
    v_cvt_pk_bf16_f32 v122, v228, v229
    v_exp_f32 v232, v232
    v_exp_f32 v233, v233
    v_cvt_pk_bf16_f32 v123, v230, v231
    v_exp_f32 v234, v234
    v_exp_f32 v235, v235
    buffer_load_dwordx4 v13, s[16:19], s49 offen offset:3072 lds
    v_mfma_f32_32x32x16_bf16 v[80:95], v[192:195], v[116:119], v[80:95]
    v_cvt_pk_bf16_f32 v124, v232, v233
    v_exp_f32 v236, v236
    v_exp_f32 v237, v237
    v_cvt_pk_bf16_f32 v125, v234, v235
    v_exp_f32 v238, v238
    v_exp_f32 v239, v239
    v_cvt_pk_bf16_f32 v126, v236, v237
    v_cvt_pk_bf16_f32 v127, v238, v239
    v_mfma_f32_32x32x16_bf16 v[208:223], a[84:87], a[64:67], 0
    v_exp_f32 v240, v240
    v_exp_f32 v241, v241
    v_exp_f32 v242, v242
    v_exp_f32 v243, v243
    v_cvt_pk_bf16_f32 v112, v240, v241
    v_exp_f32 v244, v244
    v_exp_f32 v245, v245
    v_cvt_pk_bf16_f32 v113, v242, v243
    s_add_u32 m0, s39, 12288
    s_add_u32 s49, s57, 360448
    buffer_load_dwordx4 v10, s[16:19], s49 offen offset:0 lds
    v_mfma_f32_32x32x16_bf16 v[80:95], v[148:151], v[120:123], v[80:95]
    v_exp_f32 v246, v246
    v_exp_f32 v247, v247
    v_cvt_pk_bf16_f32 v114, v244, v245
    v_exp_f32 v248, v248
    v_exp_f32 v249, v249
    v_cvt_pk_bf16_f32 v115, v246, v247
    v_exp_f32 v250, v250
    v_exp_f32 v251, v251
    buffer_load_dwordx4 v11, s[16:19], s49 offen offset:1024 lds
    v_mfma_f32_32x32x16_bf16 v[80:95], v[188:191], v[124:127], v[80:95]
    v_cvt_pk_bf16_f32 v116, v248, v249
    v_exp_f32 v252, v252
    v_exp_f32 v253, v253
    v_cvt_pk_bf16_f32 v117, v250, v251
    v_exp_f32 v254, v254
    v_exp_f32 v255, v255
    v_cvt_pk_bf16_f32 v118, v252, v253
    v_cvt_pk_bf16_f32 v119, v254, v255
    v_mfma_f32_32x32x16_bf16 v[224:239], a[80:83], a[64:67], 0
    v_exp_f32 v208, v208
    v_exp_f32 v209, v209
    v_exp_f32 v210, v210
    v_exp_f32 v211, v211
    v_cvt_pk_bf16_f32 v120, v208, v209
    v_exp_f32 v212, v212
    v_exp_f32 v213, v213
    v_cvt_pk_bf16_f32 v121, v210, v211
    buffer_load_dwordx4 v12, s[16:19], s49 offen offset:2048 lds
    v_mfma_f32_32x32x16_bf16 v[80:95], v[144:147], v[112:115], v[80:95]
    v_exp_f32 v214, v214
    v_exp_f32 v215, v215
    v_cvt_pk_bf16_f32 v122, v212, v213
    v_exp_f32 v216, v216
    v_exp_f32 v217, v217
    v_cvt_pk_bf16_f32 v123, v214, v215
    v_exp_f32 v218, v218
    v_exp_f32 v219, v219
    buffer_load_dwordx4 v13, s[16:19], s49 offen offset:3072 lds
    v_mfma_f32_32x32x16_bf16 v[80:95], v[184:187], v[116:119], v[80:95]
    v_cvt_pk_bf16_f32 v124, v216, v217
    v_exp_f32 v220, v220
    v_exp_f32 v221, v221
    v_cvt_pk_bf16_f32 v125, v218, v219
    v_exp_f32 v222, v222
    v_exp_f32 v223, v223
    v_cvt_pk_bf16_f32 v126, v220, v221
    v_cvt_pk_bf16_f32 v127, v222, v223
    v_mfma_f32_32x32x16_bf16 v[240:255], a[76:79], a[64:67], 0
    v_exp_f32 v224, v224
    v_exp_f32 v225, v225
    v_exp_f32 v226, v226
    v_exp_f32 v227, v227
    v_cvt_pk_bf16_f32 v112, v224, v225
    v_exp_f32 v228, v228
    v_exp_f32 v229, v229
    v_cvt_pk_bf16_f32 v113, v226, v227
    s_add_u32 m0, s39, 16384
    s_add_u32 s49, s57, 65536
    buffer_load_dwordx4 v10, s[16:19], s49 offen offset:0 lds
    v_mfma_f32_32x32x16_bf16 v[80:95], v[140:143], v[120:123], v[80:95]
    v_exp_f32 v230, v230
    v_exp_f32 v231, v231
    v_cvt_pk_bf16_f32 v114, v228, v229
    v_exp_f32 v232, v232
    v_exp_f32 v233, v233
    v_cvt_pk_bf16_f32 v115, v230, v231
    v_exp_f32 v234, v234
    v_exp_f32 v235, v235
    buffer_load_dwordx4 v11, s[16:19], s49 offen offset:1024 lds
    s_lshr_b32 s40, s66, 17
    s_lshl_b32 s40, s40, 2
    s_add_u32 s40, s40, s38
    s_lshl_b32 s40, s40, 9
    s_bfe_u32 s41, s66, 0x10010
    s_lshl_b32 s41, s41, 3
    s_add_u32 s40, s40, s41
    s_add_u32 s40, s40, 32768
    v_and_b32 v26, 3, v0
    v_lshlrev_b32 v26, 7, v26
    v_and_b32 v44, 4, v0
    v_add3_u32 v26, s40, v26, v44
    s_mul_i32 s46, s38, 28672
    s_add_u32 s46, s46, s59
    buffer_load_dword v25, v26, s[24:27], 0 offen sc1
    v_mfma_f32_32x32x16_bf16 v[80:95], v[180:183], v[124:127], v[80:95]
    v_cvt_pk_bf16_f32 v116, v232, v233
    v_exp_f32 v236, v236
    v_exp_f32 v237, v237
    v_cvt_pk_bf16_f32 v117, v234, v235
    v_exp_f32 v238, v238
    v_exp_f32 v239, v239
    v_cvt_pk_bf16_f32 v118, v236, v237
    v_cvt_pk_bf16_f32 v119, v238, v239
    v_mfma_f32_32x32x16_bf16 v[80:95], v[136:139], v[112:115], v[80:95]
    v_exp_f32 v240, v240
    v_exp_f32 v241, v241
    v_exp_f32 v242, v242
    v_exp_f32 v243, v243
    v_cvt_pk_bf16_f32 v120, v240, v241
    v_exp_f32 v244, v244
    buffer_load_dwordx4 v12, s[16:19], s49 offen offset:2048 lds
    v_mfma_f32_32x32x16_bf16 v[80:95], v[176:179], v[116:119], v[80:95]
    v_exp_f32 v245, v245
    v_cvt_pk_bf16_f32 v121, v242, v243
    v_exp_f32 v246, v246
    v_exp_f32 v247, v247
    v_cvt_pk_bf16_f32 v122, v244, v245
    v_exp_f32 v248, v248
    v_mfma_f32_32x32x16_bf16 v[208:223], a[76:79], a[68:71], 0
    v_exp_f32 v249, v249
    v_cvt_pk_bf16_f32 v123, v246, v247
    v_exp_f32 v250, v250
    v_exp_f32 v251, v251
    v_cvt_pk_bf16_f32 v124, v248, v249
    v_exp_f32 v252, v252
    buffer_load_dwordx4 v13, s[16:19], s49 offen offset:3072 lds
    v_mfma_f32_32x32x16_bf16 v[224:239], a[108:111], a[68:71], 0
    v_exp_f32 v253, v253
    v_cvt_pk_bf16_f32 v125, v250, v251
    v_exp_f32 v254, v254
    v_exp_f32 v255, v255
    v_cvt_pk_bf16_f32 v126, v252, v253
    v_cvt_pk_bf16_f32 v127, v254, v255
    v_mfma_f32_32x32x16_bf16 v[80:95], v[132:135], v[120:123], v[80:95]
    s_nop 0
    v_mfma_f32_32x32x16_bf16 v[80:95], v[172:175], v[124:127], v[80:95]
    s_add_u32 m0, s39, 20480
    s_add_u32 s49, s57, 98304
    buffer_load_dwordx4 v10, s[16:19], s49 offen offset:0 lds
    buffer_load_dwordx4 v11, s[16:19], s49 offen offset:1024 lds
    buffer_load_dwordx4 v12, s[16:19], s49 offen offset:2048 lds
    buffer_load_dwordx4 v13, s[16:19], s49 offen offset:3072 lds
    v_cndmask_b32 v224, v208, v224, s[68:69]
    v_cndmask_b32 v225, v209, v225, s[70:71]
    v_cndmask_b32 v226, v210, v226, s[72:73]
    v_cndmask_b32 v227, v211, v227, s[74:75]
    v_cndmask_b32 v228, v212, v228, s[76:77]
    v_cndmask_b32 v229, v213, v229, s[78:79]
    v_cndmask_b32 v230, v214, v230, s[80:81]
    v_cndmask_b32 v231, v215, v231, s[82:83]
    v_cndmask_b32 v232, v216, v232, s[84:85]
    v_cndmask_b32 v233, v217, v233, s[86:87]
    v_cndmask_b32 v234, v218, v234, s[88:89]
    v_cndmask_b32 v235, v219, v235, s[90:91]
    v_cndmask_b32 v236, v220, v236, s[92:93]
    v_cndmask_b32 v237, v221, v237, s[94:95]
    v_cndmask_b32 v238, v222, v238, s[96:97]
    v_cndmask_b32 v239, v223, v239, s[98:99]
    v_add_f32 v2, abs(v80), abs(v81)
    v_add_f32 v2, abs(v82), v2
    v_add_f32 v2, abs(v83), v2
    v_add_f32 v2, abs(v84), v2
    v_add_f32 v2, abs(v85), v2
    v_add_f32 v2, abs(v86), v2
    v_add_f32 v2, abs(v87), v2
    v_fma_f32 v2, v2, 0, v88
    v_med3_f32 v3, v2, v5, v6
    v_cmp_neq_f32 vcc, v3, v2
    s_cbranch_vccnz Lx_7o
Lx_7:
    v_mfma_f32_32x32x16_bf16 v[240:255], a[104:107], a[68:71], 0
    v_rcp_f32 v3, v88
    s_nop 0
    v_mul_f32 v80, v3, v80
    v_mul_f32 v81, v3, v81
    v_mul_f32 v82, v3, v82
    v_mul_f32 v83, v3, v83
    v_mul_f32 v84, v3, v84
    v_mul_f32 v85, v3, v85
    v_mul_f32 v86, v3, v86
    v_mul_f32 v87, v3, v87
    v_cvt_pk_bf16_f32 v36, v80, v81
    v_cvt_pk_bf16_f32 v37, v82, v83
    v_cvt_pk_bf16_f32 v38, v84, v85
    v_cvt_pk_bf16_f32 v39, v86, v87
    buffer_store_dwordx4 v[36:39], v1, s[24:27], s61 offen sc1
    s_waitcnt vmcnt(7)
    v_cmp_gt_u32 vcc, 1, v25
    s_cbranch_vccnz Lretry_24e
Lok_23:
    s_add_u32 s45, s46, 0
    buffer_load_dwordx4 a[112:115], v1, s[24:27], s45 offen offset:0 sc1
    v_exp_f32 v224, v224
    v_exp_f32 v225, v225
    v_exp_f32 v226, v226
    v_exp_f32 v227, v227
    v_cvt_pk_bf16_f32 v112, v224, v225
    v_exp_f32 v228, v228
    v_exp_f32 v229, v229
    v_cvt_pk_bf16_f32 v113, v226, v227
    v_exp_f32 v230, v230
    v_exp_f32 v231, v231
    buffer_load_dwordx4 a[116:119], v8, s[24:27], s45 offen offset:0 sc1
    v_cvt_pk_bf16_f32 v114, v228, v229
    v_exp_f32 v232, v232
    v_exp_f32 v233, v233
    v_cvt_pk_bf16_f32 v115, v230, v231
    v_exp_f32 v234, v234
    v_exp_f32 v235, v235
    v_cvt_pk_bf16_f32 v116, v232, v233
    v_exp_f32 v236, v236
    v_exp_f32 v237, v237
    v_cvt_pk_bf16_f32 v117, v234, v235
    buffer_load_dwordx4 a[120:123], v1, s[24:27], s45 offen offset:1024 sc1
    v_exp_f32 v238, v238
    v_exp_f32 v239, v239
    v_cvt_pk_bf16_f32 v118, v236, v237
    v_cvt_pk_bf16_f32 v119, v238, v239
    v_bfi_b32 v48, v56, 0, v112
    v_and_b32 v112, v56, v112
    v_bfi_b32 v49, v57, 0, v113
    v_and_b32 v113, v57, v113
    v_bfi_b32 v50, v58, 0, v114
    v_and_b32 v114, v58, v114
    v_bfi_b32 v51, v59, 0, v115
    v_and_b32 v115, v59, v115
    v_bfi_b32 v52, v60, 0, v116
    v_and_b32 v116, v60, v116
    v_bfi_b32 v53, v61, 0, v117
    v_and_b32 v117, v61, v117
    v_bfi_b32 v54, v62, 0, v118
    v_and_b32 v118, v62, v118
    v_bfi_b32 v55, v63, 0, v119
    v_and_b32 v119, v63, v119
    buffer_load_dwordx4 a[124:127], v8, s[24:27], s45 offen offset:1024 sc1
    v_mfma_f32_32x32x16_bf16 v[208:223], a[100:103], a[68:71], 0
    v_exp_f32 v240, v240
    v_exp_f32 v241, v241
    v_exp_f32 v242, v242
    v_exp_f32 v243, v243
    v_mfma_f32_32x32x16_bf16 v[80:95], v[164:167], v[112:115], 0
    v_cvt_pk_bf16_f32 v120, v240, v241
    v_exp_f32 v244, v244
    v_exp_f32 v245, v245
    v_cvt_pk_bf16_f32 v121, v242, v243
    v_exp_f32 v246, v246
    buffer_load_dwordx4 a[128:131], v1, s[24:27], s45 offen offset:2048 sc1
    v_mfma_f32_32x32x16_bf16 v[80:95], v[204:207], v[116:119], v[80:95]
    v_exp_f32 v247, v247
    v_cvt_pk_bf16_f32 v122, v244, v245
    v_exp_f32 v248, v248
    v_exp_f32 v249, v249
    v_cvt_pk_bf16_f32 v123, v246, v247
    v_mfma_f32_32x32x16_bf16 v[80:95], v[132:135], v[48:51], v[80:95]
    v_exp_f32 v250, v250
    v_exp_f32 v251, v251
    v_cvt_pk_bf16_f32 v124, v248, v249
    v_exp_f32 v252, v252
    v_exp_f32 v253, v253
    buffer_load_dwordx4 a[132:135], v8, s[24:27], s45 offen offset:2048 sc1
    v_mfma_f32_32x32x16_bf16 v[80:95], v[172:175], v[52:55], v[80:95]
    v_cvt_pk_bf16_f32 v125, v250, v251
    v_exp_f32 v254, v254
    v_exp_f32 v255, v255
    v_cvt_pk_bf16_f32 v126, v252, v253
    v_cvt_pk_bf16_f32 v127, v254, v255
    v_mfma_f32_32x32x16_bf16 v[224:239], a[96:99], a[68:71], 0
    v_exp_f32 v208, v208
    v_exp_f32 v209, v209
    v_exp_f32 v210, v210
    v_exp_f32 v211, v211
    v_cvt_pk_bf16_f32 v112, v208, v209
    v_exp_f32 v212, v212
    v_exp_f32 v213, v213
    v_cvt_pk_bf16_f32 v113, v210, v211
    buffer_load_dwordx4 a[136:139], v1, s[24:27], s45 offen offset:3072 sc1
    v_mfma_f32_32x32x16_bf16 v[80:95], v[160:163], v[120:123], v[80:95]
    v_exp_f32 v214, v214
    v_exp_f32 v215, v215
    v_cvt_pk_bf16_f32 v114, v212, v213
    v_exp_f32 v216, v216
    v_exp_f32 v217, v217
    v_cvt_pk_bf16_f32 v115, v214, v215
    v_exp_f32 v218, v218
    v_exp_f32 v219, v219
    buffer_load_dwordx4 a[140:143], v8, s[24:27], s45 offen offset:3072 sc1
    v_mfma_f32_32x32x16_bf16 v[80:95], v[200:203], v[124:127], v[80:95]
    v_cvt_pk_bf16_f32 v116, v216, v217
    v_exp_f32 v220, v220
    v_exp_f32 v221, v221
    v_cvt_pk_bf16_f32 v117, v218, v219
    v_exp_f32 v222, v222
    v_exp_f32 v223, v223
    v_cvt_pk_bf16_f32 v118, v220, v221
    v_cvt_pk_bf16_f32 v119, v222, v223
    s_add_u32 s45, s46, 8192
    buffer_load_dwordx4 a[144:147], v1, s[24:27], s45 offen offset:0 sc1
    v_mfma_f32_32x32x16_bf16 v[240:255], a[92:95], a[68:71], 0
    v_exp_f32 v224, v224
    v_exp_f32 v225, v225
    v_exp_f32 v226, v226
    v_exp_f32 v227, v227
    v_cvt_pk_bf16_f32 v120, v224, v225
    v_exp_f32 v228, v228
    v_exp_f32 v229, v229
    v_cvt_pk_bf16_f32 v121, v226, v227
    buffer_load_dwordx4 a[148:151], v8, s[24:27], s45 offen offset:0 sc1
    v_mfma_f32_32x32x16_bf16 v[80:95], v[156:159], v[112:115], v[80:95]
    v_exp_f32 v230, v230
    v_exp_f32 v231, v231
    v_cvt_pk_bf16_f32 v122, v228, v229
    v_exp_f32 v232, v232
    v_exp_f32 v233, v233
    v_cvt_pk_bf16_f32 v123, v230, v231
    v_exp_f32 v234, v234
    v_exp_f32 v235, v235
    buffer_load_dwordx4 a[152:155], v1, s[24:27], s45 offen offset:1024 sc1
    v_mfma_f32_32x32x16_bf16 v[80:95], v[196:199], v[116:119], v[80:95]
    v_cvt_pk_bf16_f32 v124, v232, v233
    v_exp_f32 v236, v236
    v_exp_f32 v237, v237
    v_cvt_pk_bf16_f32 v125, v234, v235
    v_exp_f32 v238, v238
    v_exp_f32 v239, v239
    v_cvt_pk_bf16_f32 v126, v236, v237
    v_cvt_pk_bf16_f32 v127, v238, v239
    buffer_load_dwordx4 a[156:159], v8, s[24:27], s45 offen offset:1024 sc1
    v_mfma_f32_32x32x16_bf16 v[208:223], a[88:91], a[68:71], 0
    v_exp_f32 v240, v240
    v_exp_f32 v241, v241
    v_exp_f32 v242, v242
    v_exp_f32 v243, v243
    v_cvt_pk_bf16_f32 v112, v240, v241
    v_exp_f32 v244, v244
    v_exp_f32 v245, v245
    v_cvt_pk_bf16_f32 v113, v242, v243
    buffer_load_dwordx4 a[160:163], v1, s[24:27], s45 offen offset:2048 sc1
    v_mfma_f32_32x32x16_bf16 v[80:95], v[152:155], v[120:123], v[80:95]
    v_exp_f32 v246, v246
    v_exp_f32 v247, v247
    v_cvt_pk_bf16_f32 v114, v244, v245
    v_exp_f32 v248, v248
    v_exp_f32 v249, v249
    v_cvt_pk_bf16_f32 v115, v246, v247
    v_exp_f32 v250, v250
    v_exp_f32 v251, v251
    buffer_load_dwordx4 a[164:167], v8, s[24:27], s45 offen offset:2048 sc1
    v_mfma_f32_32x32x16_bf16 v[80:95], v[192:195], v[124:127], v[80:95]
    v_cvt_pk_bf16_f32 v116, v248, v249
    v_exp_f32 v252, v252
    v_exp_f32 v253, v253
    v_cvt_pk_bf16_f32 v117, v250, v251
    v_exp_f32 v254, v254
    v_exp_f32 v255, v255
    v_cvt_pk_bf16_f32 v118, v252, v253
    v_cvt_pk_bf16_f32 v119, v254, v255
    buffer_load_dwordx4 a[168:171], v1, s[24:27], s45 offen offset:3072 sc1
    v_mfma_f32_32x32x16_bf16 v[224:239], a[84:87], a[68:71], 0
    v_exp_f32 v208, v208
    v_exp_f32 v209, v209
    v_exp_f32 v210, v210
    v_exp_f32 v211, v211
    v_cvt_pk_bf16_f32 v120, v208, v209
    v_exp_f32 v212, v212
    v_exp_f32 v213, v213
    v_cvt_pk_bf16_f32 v121, v210, v211
    buffer_load_dwordx4 a[172:175], v8, s[24:27], s45 offen offset:3072 sc1
    v_mfma_f32_32x32x16_bf16 v[80:95], v[148:151], v[112:115], v[80:95]
    v_exp_f32 v214, v214
    v_exp_f32 v215, v215
    v_cvt_pk_bf16_f32 v122, v212, v213
    v_exp_f32 v216, v216
    v_exp_f32 v217, v217
    v_cvt_pk_bf16_f32 v123, v214, v215
    v_exp_f32 v218, v218
    v_exp_f32 v219, v219
    s_add_u32 s45, s46, 16384
    buffer_load_dwordx4 a[176:179], v1, s[24:27], s45 offen offset:0 sc1
    v_mfma_f32_32x32x16_bf16 v[80:95], v[188:191], v[116:119], v[80:95]
    v_cvt_pk_bf16_f32 v124, v216, v217
    v_exp_f32 v220, v220
    v_exp_f32 v221, v221
    v_cvt_pk_bf16_f32 v125, v218, v219
    v_exp_f32 v222, v222
    v_exp_f32 v223, v223
    v_cvt_pk_bf16_f32 v126, v220, v221
    v_cvt_pk_bf16_f32 v127, v222, v223
    buffer_load_dwordx4 a[180:183], v8, s[24:27], s45 offen offset:0 sc1
    v_mfma_f32_32x32x16_bf16 v[240:255], a[80:83], a[68:71], 0
    v_exp_f32 v224, v224
    v_exp_f32 v225, v225
    v_exp_f32 v226, v226
    v_exp_f32 v227, v227
    v_cvt_pk_bf16_f32 v112, v224, v225
    v_exp_f32 v228, v228
    v_exp_f32 v229, v229
    v_cvt_pk_bf16_f32 v113, v226, v227
    buffer_load_dwordx4 a[184:187], v1, s[24:27], s45 offen offset:1024 sc1
    v_add_u32 v26, 32768, v26
    buffer_load_dword v25, v26, s[24:27], 0 offen sc1
    v_mfma_f32_32x32x16_bf16 v[80:95], v[144:147], v[120:123], v[80:95]
    v_exp_f32 v230, v230
    v_exp_f32 v231, v231
    v_cvt_pk_bf16_f32 v114, v228, v229
    v_exp_f32 v232, v232
    v_exp_f32 v233, v233
    v_cvt_pk_bf16_f32 v115, v230, v231
    v_exp_f32 v234, v234
    v_exp_f32 v235, v235
    buffer_load_dwordx4 a[188:191], v8, s[24:27], s45 offen offset:1024 sc1
    v_mfma_f32_32x32x16_bf16 v[80:95], v[184:187], v[124:127], v[80:95]
    v_cvt_pk_bf16_f32 v116, v232, v233
    v_exp_f32 v236, v236
    v_exp_f32 v237, v237
    v_cvt_pk_bf16_f32 v117, v234, v235
    v_exp_f32 v238, v238
    v_exp_f32 v239, v239
    v_cvt_pk_bf16_f32 v118, v236, v237
    v_cvt_pk_bf16_f32 v119, v238, v239
    buffer_load_dwordx4 a[32:35], v1, s[24:27], s45 offen offset:2048 sc1
    v_mfma_f32_32x32x16_bf16 v[80:95], v[140:143], v[112:115], v[80:95]
    v_exp_f32 v240, v240
    v_exp_f32 v241, v241
    v_exp_f32 v242, v242
    v_exp_f32 v243, v243
    v_cvt_pk_bf16_f32 v120, v240, v241
    v_exp_f32 v244, v244
    v_exp_f32 v245, v245
    v_cvt_pk_bf16_f32 v121, v242, v243
    v_exp_f32 v246, v246
    v_exp_f32 v247, v247
    v_cvt_pk_bf16_f32 v122, v244, v245
    v_exp_f32 v248, v248
    buffer_load_dwordx4 a[36:39], v8, s[24:27], s45 offen offset:2048 sc1
    v_mfma_f32_32x32x16_bf16 v[80:95], v[180:183], v[116:119], v[80:95]
    v_exp_f32 v249, v249
    v_cvt_pk_bf16_f32 v123, v246, v247
    v_exp_f32 v250, v250
    v_exp_f32 v251, v251
    v_cvt_pk_bf16_f32 v124, v248, v249
    v_exp_f32 v252, v252
    v_exp_f32 v253, v253
    v_cvt_pk_bf16_f32 v125, v250, v251
    v_exp_f32 v254, v254
    v_exp_f32 v255, v255
    v_cvt_pk_bf16_f32 v126, v252, v253
    v_cvt_pk_bf16_f32 v127, v254, v255
    buffer_load_dwordx4 a[40:43], v1, s[24:27], s45 offen offset:3072 sc1
    v_mfma_f32_32x32x16_bf16 v[80:95], v[136:139], v[120:123], v[80:95]
    v_mfma_f32_32x32x16_bf16 v[80:95], v[176:179], v[124:127], v[80:95]
    buffer_load_dwordx4 a[44:47], v8, s[24:27], s45 offen offset:3072 sc1
    s_add_u32 s45, s46, 20480
    buffer_load_dwordx4 a[48:51], v1, s[24:27], s45 offen offset:0 sc1
    buffer_load_dwordx4 a[60:63], v8, s[24:27], s45 offen offset:0 sc1
    buffer_load_dwordx4 a[72:75], v1, s[24:27], s45 offen offset:1024 sc1
    buffer_load_dwordx4 a[64:67], v8, s[24:27], s45 offen offset:1024 sc1
    buffer_load_dwordx4 v[128:131], v1, s[24:27], s45 offen offset:2048 sc1
    buffer_load_dwordx4 v[168:171], v8, s[24:27], s45 offen offset:2048 sc1
    ds_read_b64_tr_b16 a[0:1], v22 offset:36864
    ds_read_b64_tr_b16 a[2:3], v22 offset:37888
    ds_read_b64_tr_b16 a[4:5], v23 offset:36864
    ds_read_b64_tr_b16 a[6:7], v23 offset:37888
    ds_read_b64_tr_b16 a[8:9], v22 offset:38912
    ds_read_b64_tr_b16 a[10:11], v22 offset:39936
    ds_read_b64_tr_b16 a[12:13], v23 offset:38912
    ds_read_b64_tr_b16 a[14:15], v23 offset:39936
    v_add_f32 v2, abs(v80), abs(v81)
    v_add_f32 v2, abs(v82), v2
    v_add_f32 v2, abs(v83), v2
    v_add_f32 v2, abs(v84), v2
    v_add_f32 v2, abs(v85), v2
    v_add_f32 v2, abs(v86), v2
    v_add_f32 v2, abs(v87), v2
    v_fma_f32 v2, v2, 0, v88
    v_med3_f32 v3, v2, v5, v6
    v_cmp_neq_f32 vcc, v3, v2
    s_cbranch_vccnz Lx_16o
Lx_16:
    v_rcp_f32 v3, v88
    s_nop 0
    v_mul_f32 v80, v3, v80
    v_mul_f32 v81, v3, v81
    v_mul_f32 v82, v3, v82
    v_mul_f32 v83, v3, v83
    v_mul_f32 v84, v3, v84
    v_mul_f32 v85, v3, v85
    v_mul_f32 v86, v3, v86
    v_mul_f32 v87, v3, v87
    v_cvt_pk_bf16_f32 v36, v80, v81
    v_cvt_pk_bf16_f32 v37, v82, v83
    v_cvt_pk_bf16_f32 v38, v84, v85
    v_cvt_pk_bf16_f32 v39, v86, v87
    buffer_store_dwordx4 v[36:39], v8, s[24:27], s61 offen sc1
    s_waitcnt vmcnt(31) lgkmcnt(6)
    v_mfma_f32_32x32x16_bf16 v[64:79], a[0:3], a[112:115], 0
    ds_read_b64_tr_b16 a[16:17], v22 offset:0
    s_waitcnt lgkmcnt(5)
    v_mfma_f32_32x32x16_bf16 v[80:95], a[4:7], a[112:115], 0
    ds_read_b64_tr_b16 a[18:19], v22 offset:1024
    s_waitcnt vmcnt(30)
    v_mfma_f32_32x32x16_bf16 v[96:111], a[0:3], a[116:119], 0
    ds_read_b64_tr_b16 a[20:21], v23 offset:0
    v_mfma_f32_32x32x16_bf16 v[112:127], a[4:7], a[116:119], 0
    ds_read_b64_tr_b16 a[22:23], v23 offset:1024
    buffer_load_dwordx4 a[112:115], v1, s[24:27], s45 offen offset:3072 sc1
    s_waitcnt vmcnt(30) lgkmcnt(6)
    v_mfma_f32_32x32x16_bf16 v[64:79], a[8:11], a[120:123], v[64:79]
    ds_read_b64_tr_b16 a[24:25], v22 offset:2048
    s_waitcnt lgkmcnt(5)
    v_mfma_f32_32x32x16_bf16 v[80:95], a[12:15], a[120:123], v[80:95]
    ds_read_b64_tr_b16 a[26:27], v22 offset:3072
    buffer_load_dwordx4 a[116:119], v8, s[24:27], s45 offen offset:3072 sc1
    s_waitcnt vmcnt(30)
    v_mfma_f32_32x32x16_bf16 v[96:111], a[8:11], a[124:127], v[96:111]
    ds_read_b64_tr_b16 a[28:29], v23 offset:2048
    s_waitcnt vmcnt(14)
    v_cmp_gt_u32 vcc, 1, v25
    s_cbranch_vccnz Lretry_26e
Lok_25:
    v_mfma_f32_32x32x16_bf16 v[112:127], a[12:15], a[124:127], v[112:127]
    ds_read_b64_tr_b16 a[30:31], v23 offset:3072
    s_lshr_b32 s40, s66, 18
    s_add_u32 s45, s46, 4096
    buffer_load_dwordx4 a[120:123], v1, s[24:27], s45 offen offset:0 sc1
    s_waitcnt lgkmcnt(6)
    v_mfma_f32_32x32x16_bf16 v[64:79], a[16:19], a[128:131], v[64:79]
    ds_read_b64_tr_b16 a[0:1], v22 offset:4096
    s_lshl4_add_u32 s40, s40, s38
    s_waitcnt lgkmcnt(5)
    v_mfma_f32_32x32x16_bf16 v[80:95], a[20:23], a[128:131], v[80:95]
    ds_read_b64_tr_b16 a[2:3], v22 offset:5120
    s_lshl_b32 s40, s40, 8
    buffer_load_dwordx4 a[124:127], v8, s[24:27], s45 offen offset:0 sc1
    v_mfma_f32_32x32x16_bf16 v[96:111], a[16:19], a[132:135], v[96:111]
    ds_read_b64_tr_b16 a[4:5], v23 offset:4096
    s_bfe_u32 s47, s66, 0x20010
    v_mfma_f32_32x32x16_bf16 v[112:127], a[20:23], a[132:135], v[112:127]
    ds_read_b64_tr_b16 a[6:7], v23 offset:5120
    s_lshl2_add_u32 s40, s47, s40
    buffer_load_dwordx4 a[128:131], v1, s[24:27], s45 offen offset:1024 sc1
    s_waitcnt lgkmcnt(6)
    v_mfma_f32_32x32x16_bf16 v[64:79], a[24:27], a[136:139], v[64:79]
    ds_read_b64_tr_b16 a[8:9], v22 offset:6144
    s_add_u32 s40, s40, 98304
    s_waitcnt lgkmcnt(5)
    v_mfma_f32_32x32x16_bf16 v[80:95], a[28:31], a[136:139], v[80:95]
    ds_read_b64_tr_b16 a[10:11], v22 offset:7168
    v_and_b32 v26, 3, v0
    buffer_load_dwordx4 a[132:135], v8, s[24:27], s45 offen offset:1024 sc1
    v_mfma_f32_32x32x16_bf16 v[96:111], a[24:27], a[140:143], v[96:111]
    ds_read_b64_tr_b16 a[12:13], v23 offset:6144
    v_lshlrev_b32 v26, 10, v26
    v_mfma_f32_32x32x16_bf16 v[112:127], a[28:31], a[140:143], v[112:127]
    ds_read_b64_tr_b16 a[14:15], v23 offset:7168
    v_and_b32 v44, 4, v0
    buffer_load_dwordx4 a[136:139], v1, s[24:27], s45 offen offset:2048 sc1
    s_waitcnt lgkmcnt(6)
    v_mfma_f32_32x32x16_bf16 v[64:79], a[0:3], a[144:147], v[64:79]
    ds_read_b64_tr_b16 a[16:17], v22 offset:8192
    v_lshlrev_b32 v44, 5, v44
    s_waitcnt lgkmcnt(5)
    v_mfma_f32_32x32x16_bf16 v[80:95], a[4:7], a[144:147], v[80:95]
    ds_read_b64_tr_b16 a[18:19], v22 offset:9216
    v_add3_u32 v26, s40, v26, v44
    buffer_load_dwordx4 a[140:143], v8, s[24:27], s45 offen offset:2048 sc1
    v_mfma_f32_32x32x16_bf16 v[96:111], a[0:3], a[148:151], v[96:111]
    ds_read_b64_tr_b16 a[20:21], v23 offset:8192
    s_lshl_b32 s47, s38, 13
    v_mfma_f32_32x32x16_bf16 v[112:127], a[4:7], a[148:151], v[112:127]
    ds_read_b64_tr_b16 a[22:23], v23 offset:9216
    s_add_u32 s47, s47, s59
    buffer_load_dwordx4 a[144:147], v1, s[24:27], s45 offen offset:3072 sc1
    s_waitcnt lgkmcnt(6)
    v_mfma_f32_32x32x16_bf16 v[64:79], a[8:11], a[152:155], v[64:79]
    ds_read_b64_tr_b16 a[24:25], v22 offset:10240
    s_add_u32 s47, s47, 114688
    s_waitcnt lgkmcnt(5)
    v_mfma_f32_32x32x16_bf16 v[80:95], a[12:15], a[152:155], v[80:95]
    ds_read_b64_tr_b16 a[26:27], v22 offset:11264
    s_add_u32 s48, s47, 4096
    buffer_load_dwordx4 a[148:151], v8, s[24:27], s45 offen offset:3072 sc1
    v_mfma_f32_32x32x16_bf16 v[96:111], a[8:11], a[156:159], v[96:111]
    ds_read_b64_tr_b16 a[28:29], v23 offset:10240
    v_mfma_f32_32x32x16_bf16 v[112:127], a[12:15], a[156:159], v[112:127]
    ds_read_b64_tr_b16 a[30:31], v23 offset:11264
    s_add_u32 s45, s46, 12288
    buffer_load_dwordx4 a[152:155], v1, s[24:27], s45 offen offset:0 sc1
    s_waitcnt lgkmcnt(6)
    v_mfma_f32_32x32x16_bf16 v[64:79], a[16:19], a[160:163], v[64:79]
    ds_read_b64_tr_b16 a[0:1], v22 offset:32768
    s_add_u32 s65, s65, 32768
    s_waitcnt vmcnt(11)
    v_mov_b32 v4, 1
    s_mov_b64 exec, 1
    buffer_store_dword v4, off, s[24:27], s65 sc1
    s_mov_b64 exec, -1
    s_waitcnt lgkmcnt(5)
    v_mfma_f32_32x32x16_bf16 v[80:95], a[20:23], a[160:163], v[80:95]
    ds_read_b64_tr_b16 a[2:3], v22 offset:33792
    buffer_load_dwordx4 a[156:159], v8, s[24:27], s45 offen offset:0 sc1
    v_mfma_f32_32x32x16_bf16 v[96:111], a[16:19], a[164:167], v[96:111]
    ds_read_b64_tr_b16 a[4:5], v23 offset:32768
    v_mfma_f32_32x32x16_bf16 v[112:127], a[20:23], a[164:167], v[112:127]
    ds_read_b64_tr_b16 a[6:7], v23 offset:33792
    buffer_load_dwordx4 a[160:163], v1, s[24:27], s45 offen offset:1024 sc1
    s_waitcnt lgkmcnt(6)
    v_mfma_f32_32x32x16_bf16 v[64:79], a[24:27], a[168:171], v[64:79]
    ds_read_b64_tr_b16 a[8:9], v22 offset:34816
    s_waitcnt lgkmcnt(5)
    v_mfma_f32_32x32x16_bf16 v[80:95], a[28:31], a[168:171], v[80:95]
    ds_read_b64_tr_b16 a[10:11], v22 offset:35840
    buffer_load_dwordx4 a[164:167], v8, s[24:27], s45 offen offset:1024 sc1
    v_mfma_f32_32x32x16_bf16 v[96:111], a[24:27], a[172:175], v[96:111]
    ds_read_b64_tr_b16 a[12:13], v23 offset:34816
    v_mfma_f32_32x32x16_bf16 v[112:127], a[28:31], a[172:175], v[112:127]
    ds_read_b64_tr_b16 a[14:15], v23 offset:35840
    buffer_load_dwordx4 a[168:171], v1, s[24:27], s45 offen offset:2048 sc1
    s_waitcnt lgkmcnt(6)
    v_mfma_f32_32x32x16_bf16 v[64:79], a[0:3], a[176:179], v[64:79]
    ds_read_b64_tr_b16 a[16:17], v22 offset:24576
    s_waitcnt lgkmcnt(5)
    v_mfma_f32_32x32x16_bf16 v[80:95], a[4:7], a[176:179], v[80:95]
    ds_read_b64_tr_b16 a[18:19], v22 offset:25600
    buffer_load_dwordx4 a[172:175], v8, s[24:27], s45 offen offset:2048 sc1
    v_mfma_f32_32x32x16_bf16 v[96:111], a[0:3], a[180:183], v[96:111]
    ds_read_b64_tr_b16 a[20:21], v23 offset:24576
    v_mfma_f32_32x32x16_bf16 v[112:127], a[4:7], a[180:183], v[112:127]
    ds_read_b64_tr_b16 a[22:23], v23 offset:25600
    buffer_load_dwordx4 a[176:179], v1, s[24:27], s45 offen offset:3072 sc1
    s_waitcnt lgkmcnt(6)
    v_mfma_f32_32x32x16_bf16 v[64:79], a[8:11], a[184:187], v[64:79]
    ds_read_b64_tr_b16 a[24:25], v22 offset:26624
    v_lshrrev_b32 v46, 3, v0
    s_waitcnt lgkmcnt(5)
    v_mfma_f32_32x32x16_bf16 v[80:95], a[12:15], a[184:187], v[80:95]
    ds_read_b64_tr_b16 a[26:27], v22 offset:27648
    buffer_load_dwordx4 a[180:183], v8, s[24:27], s45 offen offset:3072 sc1
    v_and_b32 v47, 7, v0
    v_mfma_f32_32x32x16_bf16 v[96:111], a[8:11], a[188:191], v[96:111]
    ds_read_b64_tr_b16 a[28:29], v23 offset:26624
    v_lshlrev_b32 v47, 4, v47
    v_mfma_f32_32x32x16_bf16 v[112:127], a[12:15], a[188:191], v[112:127]
    ds_read_b64_tr_b16 a[30:31], v23 offset:27648
    s_add_u32 s45, s46, 24576
    buffer_load_dwordx4 a[184:187], v1, s[24:27], s45 offen offset:0 sc1
    v_lshl_add_u32 v42, v46, 10, v47
    s_waitcnt lgkmcnt(6)
    v_mfma_f32_32x32x16_bf16 v[64:79], a[16:19], a[32:35], v[64:79]
    ds_read_b64_tr_b16 a[0:1], v22 offset:28672
    s_and_b32 s40, s66, 0x3ff
    s_waitcnt lgkmcnt(5)
    v_mfma_f32_32x32x16_bf16 v[80:95], a[20:23], a[32:35], v[80:95]
    ds_read_b64_tr_b16 a[2:3], v22 offset:29696
    buffer_load_dwordx4 a[188:191], v8, s[24:27], s45 offen offset:0 sc1
    v_add_u32 v47, s40, v47
    v_mfma_f32_32x32x16_bf16 v[96:111], a[16:19], a[36:39], v[96:111]
    ds_read_b64_tr_b16 a[4:5], v23 offset:28672
    global_load_dwordx4 v[28:31], v47, s[34:35]
    v_mfma_f32_32x32x16_bf16 v[112:127], a[20:23], a[36:39], v[112:127]
    ds_read_b64_tr_b16 a[6:7], v23 offset:29696
    buffer_load_dwordx4 a[32:35], v1, s[24:27], s45 offen offset:1024 sc1
    v_and_b32 v46, 31, v0
    s_waitcnt lgkmcnt(6)
    v_mfma_f32_32x32x16_bf16 v[64:79], a[24:27], a[40:43], v[64:79]
    ds_read_b64_tr_b16 a[8:9], v22 offset:30720
    v_lshlrev_b32 v46, 8, v46
    s_waitcnt lgkmcnt(5)
    v_mfma_f32_32x32x16_bf16 v[80:95], a[28:31], a[40:43], v[80:95]
    ds_read_b64_tr_b16 a[10:11], v22 offset:31744
    buffer_load_dwordx4 a[36:39], v8, s[24:27], s45 offen offset:1024 sc1
    v_add_u32 v46, s39, v46
    v_mfma_f32_32x32x16_bf16 v[96:111], a[24:27], a[44:47], v[96:111]
    ds_read_b64_tr_b16 a[12:13], v23 offset:30720
    v_lshrrev_b32 v47, 5, v0
    v_mfma_f32_32x32x16_bf16 v[112:127], a[28:31], a[44:47], v[112:127]
    ds_read_b64_tr_b16 a[14:15], v23 offset:31744
    buffer_load_dwordx4 a[40:43], v1, s[24:27], s45 offen offset:2048 sc1
    v_xor_b32 v47, v47, v0
    s_waitcnt lgkmcnt(6)
    v_mfma_f32_32x32x16_bf16 v[64:79], a[0:3], a[48:51], v[64:79]
    ds_read_b64_tr_b16 a[16:17], v22 offset:12288
    s_add_u32 m0, s39, 36864
    s_add_u32 s49, s57, 196608
    buffer_load_dwordx4 v10, s[16:19], s49 offen offset:0 lds
    s_waitcnt lgkmcnt(5)
    v_mfma_f32_32x32x16_bf16 v[80:95], a[4:7], a[48:51], v[80:95]
    ds_read_b64_tr_b16 a[18:19], v22 offset:13312
    buffer_load_dwordx4 a[44:47], v8, s[24:27], s45 offen offset:2048 sc1
    v_and_b32 v47, 7, v47
    v_mfma_f32_32x32x16_bf16 v[96:111], a[0:3], a[60:63], v[96:111]
    ds_read_b64_tr_b16 a[20:21], v23 offset:12288
    buffer_load_dwordx4 v11, s[16:19], s49 offen offset:1024 lds
    v_lshl_add_u32 v34, v47, 4, v46
    v_mfma_f32_32x32x16_bf16 v[112:127], a[4:7], a[60:63], v[112:127]
    ds_read_b64_tr_b16 a[22:23], v23 offset:13312
    buffer_load_dwordx4 a[48:51], v1, s[24:27], s45 offen offset:3072 sc1
    v_xor_b32 v35, 32, v34
    s_waitcnt lgkmcnt(6)
    v_mfma_f32_32x32x16_bf16 v[64:79], a[8:11], a[72:75], v[64:79]
    ds_read_b64_tr_b16 a[24:25], v22 offset:14336
    buffer_load_dwordx4 v12, s[16:19], s49 offen offset:2048 lds
    v_xor_b32 v36, 64, v34
    s_waitcnt lgkmcnt(5)
    v_mfma_f32_32x32x16_bf16 v[80:95], a[12:15], a[72:75], v[80:95]
    ds_read_b64_tr_b16 a[26:27], v22 offset:15360
    buffer_load_dwordx4 a[60:63], v8, s[24:27], s45 offen offset:3072 sc1
    v_xor_b32 v37, 0x60, v34
    v_mfma_f32_32x32x16_bf16 v[96:111], a[8:11], a[64:67], v[96:111]
    ds_read_b64_tr_b16 a[28:29], v23 offset:14336
    buffer_load_dwordx4 v13, s[16:19], s49 offen offset:3072 lds
    v_lshrrev_b32 v46, 3, v0
    v_mfma_f32_32x32x16_bf16 v[112:127], a[12:15], a[64:67], v[112:127]
    ds_read_b64_tr_b16 a[30:31], v23 offset:15360
    s_add_u32 m0, s39, 0
    v_and_b32 v47, 7, v0
    s_waitcnt lgkmcnt(6)
    v_mfma_f32_32x32x16_bf16 v[64:79], a[16:19], v[128:131], v[64:79]
    ds_read_b64_tr_b16 a[0:1], v22 offset:16384
    s_add_u32 s49, s57, 229376
    v_lshlrev_b32 v47, 1, v47
    s_waitcnt lgkmcnt(5)
    v_mfma_f32_32x32x16_bf16 v[80:95], a[20:23], v[128:131], v[80:95]
    ds_read_b64_tr_b16 a[2:3], v22 offset:17408
    buffer_load_dwordx4 v10, s[16:19], s49 offen offset:0 lds
    v_xor_b32 v47, v47, v46
    v_mfma_f32_32x32x16_bf16 v[96:111], a[16:19], v[168:171], v[96:111]
    ds_read_b64_tr_b16 a[4:5], v23 offset:16384
    buffer_load_dwordx4 v11, s[16:19], s49 offen offset:1024 lds
    v_lshlrev_b32 v47, 4, v47
    v_mfma_f32_32x32x16_bf16 v[112:127], a[20:23], v[168:171], v[112:127]
    ds_read_b64_tr_b16 a[6:7], v23 offset:17408
    v_lshl_add_u32 v46, v46, 8, v47
    s_waitcnt vmcnt(33) lgkmcnt(6)
    v_mfma_f32_32x32x16_bf16 v[64:79], a[24:27], a[112:115], v[64:79]
    ds_read_b64_tr_b16 a[8:9], v22 offset:18432
    buffer_load_dwordx4 v12, s[16:19], s49 offen offset:2048 lds
    s_lshl_b32 s40, s38, 11
    s_waitcnt lgkmcnt(5)
    v_mfma_f32_32x32x16_bf16 v[80:95], a[28:31], a[112:115], v[80:95]
    ds_read_b64_tr_b16 a[10:11], v22 offset:19456
    v_add_u32 v38, s40, v46
    s_waitcnt vmcnt(33)
    v_mfma_f32_32x32x16_bf16 v[96:111], a[24:27], a[116:119], v[96:111]
    ds_read_b64_tr_b16 a[12:13], v23 offset:18432
    buffer_load_dwordx4 v13, s[16:19], s49 offen offset:3072 lds
    v_xor_b32 v39, 16, v38
    v_mfma_f32_32x32x16_bf16 v[112:127], a[28:31], a[116:119], v[112:127]
    ds_read_b64_tr_b16 a[14:15], v23 offset:19456
    s_add_u32 m0, s39, 4096
    v_add_u32 v40, 81920, v38
    s_waitcnt vmcnt(33) lgkmcnt(6)
    v_mfma_f32_32x32x16_bf16 v[64:79], a[0:3], a[120:123], v[64:79]
    ds_read_b64_tr_b16 a[16:17], v22 offset:20480
    s_add_u32 s49, s57, 393216
    v_add_u32 v41, 81920, v39
    s_waitcnt lgkmcnt(5)
    v_mfma_f32_32x32x16_bf16 v[80:95], a[4:7], a[120:123], v[80:95]
    ds_read_b64_tr_b16 a[18:19], v22 offset:21504
    buffer_load_dwordx4 v10, s[16:19], s49 offen offset:0 lds
    s_waitcnt vmcnt(33)
    v_mfma_f32_32x32x16_bf16 v[96:111], a[0:3], a[124:127], v[96:111]
    ds_read_b64_tr_b16 a[20:21], v23 offset:20480
    buffer_load_dwordx4 v11, s[16:19], s49 offen offset:1024 lds
    v_mfma_f32_32x32x16_bf16 v[112:127], a[4:7], a[124:127], v[112:127]
    ds_read_b64_tr_b16 a[22:23], v23 offset:21504
    s_waitcnt vmcnt(33) lgkmcnt(6)
    v_mfma_f32_32x32x16_bf16 v[64:79], a[8:11], a[128:131], v[64:79]
    ds_read_b64_tr_b16 a[24:25], v22 offset:22528
    v_add_u32 v26, 32768, v26
    buffer_load_dword v25, v26, s[24:27], 0 offen sc1
    s_waitcnt lgkmcnt(5)
    v_mfma_f32_32x32x16_bf16 v[80:95], a[12:15], a[128:131], v[80:95]
    ds_read_b64_tr_b16 a[26:27], v22 offset:23552
    buffer_load_dwordx4 v12, s[16:19], s49 offen offset:2048 lds
    s_waitcnt vmcnt(34)
    v_mfma_f32_32x32x16_bf16 v[96:111], a[8:11], a[132:135], v[96:111]
    ds_read_b64_tr_b16 a[28:29], v23 offset:22528
    buffer_load_dwordx4 v13, s[16:19], s49 offen offset:3072 lds
    v_mfma_f32_32x32x16_bf16 v[112:127], a[12:15], a[132:135], v[112:127]
    ds_read_b64_tr_b16 a[30:31], v23 offset:23552
    s_add_u32 m0, s39, 8192
    s_waitcnt vmcnt(34) lgkmcnt(6)
    v_mfma_f32_32x32x16_bf16 v[64:79], a[16:19], a[136:139], v[64:79]
    s_waitcnt vmcnt(9)
    ds_read_b64_tr_b16 a[0:1], v22 offset:36864
    s_add_u32 s49, s57, 425984
    s_waitcnt lgkmcnt(5)
    v_mfma_f32_32x32x16_bf16 v[80:95], a[20:23], a[136:139], v[80:95]
    ds_read_b64_tr_b16 a[2:3], v22 offset:37888
    buffer_load_dwordx4 v10, s[16:19], s49 offen offset:0 lds
    v_mfma_f32_32x32x16_bf16 v[96:111], a[16:19], a[140:143], v[96:111]
    ds_read_b64_tr_b16 a[4:5], v23 offset:36864
    buffer_load_dwordx4 v11, s[16:19], s49 offen offset:1024 lds
    v_mfma_f32_32x32x16_bf16 v[112:127], a[20:23], a[140:143], v[112:127]
    ds_read_b64_tr_b16 a[6:7], v23 offset:37888
    s_waitcnt lgkmcnt(6)
    v_mfma_f32_32x32x16_bf16 v[64:79], a[24:27], a[144:147], v[64:79]
    ds_read_b64_tr_b16 a[8:9], v22 offset:38912
    buffer_load_dwordx4 v12, s[16:19], s49 offen offset:2048 lds
    s_waitcnt lgkmcnt(5)
    v_mfma_f32_32x32x16_bf16 v[80:95], a[28:31], a[144:147], v[80:95]
    ds_read_b64_tr_b16 a[10:11], v22 offset:39936
    v_mfma_f32_32x32x16_bf16 v[96:111], a[24:27], a[148:151], v[96:111]
    ds_read_b64_tr_b16 a[12:13], v23 offset:38912
    buffer_load_dwordx4 v13, s[16:19], s49 offen offset:3072 lds
    v_mfma_f32_32x32x16_bf16 v[112:127], a[28:31], a[148:151], v[112:127]
    ds_read_b64_tr_b16 a[14:15], v23 offset:39936
    s_waitcnt lgkmcnt(6)
    v_mfma_f32_32x32x16_bf16 v[64:79], a[0:3], a[152:155], v[64:79]
    s_waitcnt vmcnt(9)
    ds_read_b64_tr_b16 a[16:17], v22 offset:0
    s_waitcnt lgkmcnt(5)
    v_mfma_f32_32x32x16_bf16 v[80:95], a[4:7], a[152:155], v[80:95]
    ds_read_b64_tr_b16 a[18:19], v22 offset:1024
    v_mfma_f32_32x32x16_bf16 v[96:111], a[0:3], a[156:159], v[96:111]
    ds_read_b64_tr_b16 a[20:21], v23 offset:0
    v_mfma_f32_32x32x16_bf16 v[112:127], a[4:7], a[156:159], v[112:127]
    ds_read_b64_tr_b16 a[22:23], v23 offset:1024
    s_waitcnt lgkmcnt(6)
    v_mfma_f32_32x32x16_bf16 v[64:79], a[8:11], a[160:163], v[64:79]
    ds_read_b64_tr_b16 a[24:25], v22 offset:2048
    s_waitcnt lgkmcnt(5)
    v_mfma_f32_32x32x16_bf16 v[80:95], a[12:15], a[160:163], v[80:95]
    ds_read_b64_tr_b16 a[26:27], v22 offset:3072
    v_mfma_f32_32x32x16_bf16 v[96:111], a[8:11], a[164:167], v[96:111]
    ds_read_b64_tr_b16 a[28:29], v23 offset:2048
    v_mfma_f32_32x32x16_bf16 v[112:127], a[12:15], a[164:167], v[112:127]
    ds_read_b64_tr_b16 a[30:31], v23 offset:3072
    s_waitcnt lgkmcnt(6)
    v_mfma_f32_32x32x16_bf16 v[64:79], a[16:19], a[168:171], v[64:79]
    s_waitcnt vmcnt(4)
    ds_read_b64_tr_b16 a[0:1], v22 offset:4096
    v_cmp_gt_u32 vcc, 1, v25
    s_cbranch_vccnz Lretry_28e
Lok_27:
    s_waitcnt lgkmcnt(5)
    v_mfma_f32_32x32x16_bf16 v[80:95], a[20:23], a[168:171], v[80:95]
    ds_read_b64_tr_b16 a[2:3], v22 offset:5120
    buffer_load_dwordx4 a[72:75], v1, s[24:27], s47 offen offset:0 sc1
    v_lshlrev_b32 v44, 16, v28
    v_and_b32 v45, s44, v28
    v_mfma_f32_32x32x16_bf16 v[96:111], a[16:19], a[172:175], v[96:111]
    ds_read_b64_tr_b16 a[4:5], v23 offset:4096
    buffer_load_dwordx4 v[128:131], v1, s[24:27], s47 offen offset:1024 sc1
    v_accvgpr_read_b32 v49, a52
    v_lshlrev_b32 v48, 16, v49
    v_mfma_f32_32x32x16_bf16 v[112:127], a[20:23], a[172:175], v[112:127]
    ds_read_b64_tr_b16 a[6:7], v23 offset:5120
    buffer_load_dwordx4 a[112:115], v1, s[24:27], s47 offen offset:2048 sc1
    v_and_b32 v49, s44, v49
    v_add_f32 v48, v48, v44
    s_waitcnt lgkmcnt(6)
    v_mfma_f32_32x32x16_bf16 v[64:79], a[24:27], a[176:179], v[64:79]
    ds_read_b64_tr_b16 a[8:9], v22 offset:6144
    v_add_f32 v49, v49, v45
    v_accvgpr_read_b32 v57, a56
    v_lshlrev_b32 v56, 16, v57
    s_waitcnt lgkmcnt(5)
    v_mfma_f32_32x32x16_bf16 v[80:95], a[28:31], a[176:179], v[80:95]
    ds_read_b64_tr_b16 a[10:11], v22 offset:7168
    buffer_load_dwordx4 a[120:123], v1, s[24:27], s47 offen offset:3072 sc1
    v_and_b32 v57, s44, v57
    v_add_f32 v56, v56, v44
    v_mfma_f32_32x32x16_bf16 v[96:111], a[24:27], a[180:183], v[96:111]
    ds_read_b64_tr_b16 a[12:13], v23 offset:6144
    buffer_load_dwordx4 a[128:131], v1, s[24:27], s48 offen offset:0 sc1
    v_add_f32 v57, v57, v45
    v_lshlrev_b32 v44, 16, v29
    v_mfma_f32_32x32x16_bf16 v[112:127], a[28:31], a[180:183], v[112:127]
    ds_read_b64_tr_b16 a[14:15], v23 offset:7168
    buffer_load_dwordx4 a[136:139], v1, s[24:27], s48 offen offset:1024 sc1
    v_and_b32 v45, s44, v29
    v_accvgpr_read_b32 v51, a53
    s_waitcnt lgkmcnt(6)
    v_mfma_f32_32x32x16_bf16 v[64:79], a[0:3], a[184:187], v[64:79]
    s_waitcnt vmcnt(6)
    ds_read_b64_tr_b16 a[16:17], v22 offset:8192
    buffer_load_dwordx4 a[144:147], v1, s[24:27], s48 offen offset:2048 sc1
    v_lshlrev_b32 v50, 16, v51
    s_waitcnt lgkmcnt(5)
    v_mfma_f32_32x32x16_bf16 v[80:95], a[4:7], a[184:187], v[80:95]
    ds_read_b64_tr_b16 a[18:19], v22 offset:9216
    v_and_b32 v51, s44, v51
    v_add_f32 v50, v50, v44
    v_add_f32 v51, v51, v45
    v_mfma_f32_32x32x16_bf16 v[96:111], a[0:3], a[188:191], v[96:111]
    ds_read_b64_tr_b16 a[20:21], v23 offset:8192
    buffer_load_dwordx4 a[152:155], v1, s[24:27], s48 offen offset:3072 sc1
    v_accvgpr_read_b32 v59, a57
    v_lshlrev_b32 v58, 16, v59
    v_mfma_f32_32x32x16_bf16 v[112:127], a[4:7], a[188:191], v[112:127]
    ds_read_b64_tr_b16 a[22:23], v23 offset:9216
    buffer_load_dwordx4 a[64:67], v8, s[24:27], s47 offen offset:0 sc1
    v_and_b32 v59, s44, v59
    v_add_f32 v58, v58, v44
    s_waitcnt lgkmcnt(6)
    v_mfma_f32_32x32x16_bf16 v[64:79], a[8:11], a[32:35], v[64:79]
    ds_read_b64_tr_b16 a[24:25], v22 offset:10240
    buffer_load_dwordx4 v[168:171], v8, s[24:27], s47 offen offset:1024 sc1
    v_add_f32 v59, v59, v45
    v_lshlrev_b32 v44, 16, v30
    s_waitcnt lgkmcnt(5)
    v_mfma_f32_32x32x16_bf16 v[80:95], a[12:15], a[32:35], v[80:95]
    ds_read_b64_tr_b16 a[26:27], v22 offset:11264
    v_and_b32 v45, s44, v30
    v_accvgpr_read_b32 v53, a54
    v_lshlrev_b32 v52, 16, v53
    v_mfma_f32_32x32x16_bf16 v[96:111], a[8:11], a[36:39], v[96:111]
    ds_read_b64_tr_b16 a[28:29], v23 offset:10240
    buffer_load_dwordx4 a[116:119], v8, s[24:27], s47 offen offset:2048 sc1
    v_and_b32 v53, s44, v53
    v_add_f32 v52, v52, v44
    v_mfma_f32_32x32x16_bf16 v[112:127], a[12:15], a[36:39], v[112:127]
    ds_read_b64_tr_b16 a[30:31], v23 offset:11264
    buffer_load_dwordx4 a[124:127], v8, s[24:27], s47 offen offset:3072 sc1
    v_add_f32 v53, v53, v45
    v_accvgpr_read_b32 v61, a58
    s_waitcnt lgkmcnt(6)
    v_mfma_f32_32x32x16_bf16 v[64:79], a[16:19], a[40:43], v[64:79]
    v_lshlrev_b32 v60, 16, v61
    v_and_b32 v61, s44, v61
    s_waitcnt lgkmcnt(4)
    v_mfma_f32_32x32x16_bf16 v[80:95], a[20:23], a[40:43], v[80:95]
    buffer_load_dwordx4 a[132:135], v8, s[24:27], s48 offen offset:0 sc1
    v_add_f32 v60, v60, v44
    v_add_f32 v61, v61, v45
    v_mfma_f32_32x32x16_bf16 v[96:111], a[16:19], a[44:47], v[96:111]
    buffer_load_dwordx4 a[140:143], v8, s[24:27], s48 offen offset:1024 sc1
    v_lshlrev_b32 v44, 16, v31
    v_and_b32 v45, s44, v31
    v_mfma_f32_32x32x16_bf16 v[112:127], a[20:23], a[44:47], v[112:127]
    buffer_load_dwordx4 a[148:151], v8, s[24:27], s48 offen offset:2048 sc1
    v_accvgpr_read_b32 v55, a55
    v_lshlrev_b32 v54, 16, v55
    s_waitcnt lgkmcnt(2)
    v_mfma_f32_32x32x16_bf16 v[64:79], a[24:27], a[48:51], v[64:79]
    v_and_b32 v55, s44, v55
    v_add_f32 v54, v54, v44
    s_waitcnt lgkmcnt(0)
    v_mfma_f32_32x32x16_bf16 v[80:95], a[28:31], a[48:51], v[80:95]
    buffer_load_dwordx4 a[156:159], v8, s[24:27], s48 offen offset:3072 sc1
    v_add_f32 v55, v55, v45
    v_accvgpr_read_b32 v63, a59
    v_mfma_f32_32x32x16_bf16 v[96:111], a[24:27], a[60:63], v[96:111]
    v_lshlrev_b32 v62, 16, v63
    v_and_b32 v63, s44, v63
    v_mfma_f32_32x32x16_bf16 v[112:127], a[28:31], a[60:63], v[112:127]
    v_add_f32 v62, v62, v44
    v_add_f32 v63, v63, v45
    s_waitcnt vmcnt(15)
    v_mfma_f32_32x32x16_bf16 v[64:79], a[192:195], a[72:75], v[64:79]
    s_waitcnt vmcnt(14)
    v_mfma_f32_32x32x16_bf16 v[64:79], a[200:203], v[128:131], v[64:79]
    s_waitcnt vmcnt(13)
    v_mfma_f32_32x32x16_bf16 v[64:79], a[208:211], a[112:115], v[64:79]
    s_waitcnt vmcnt(12)
    v_mfma_f32_32x32x16_bf16 v[64:79], a[216:219], a[120:123], v[64:79]
    s_waitcnt vmcnt(11)
    v_mfma_f32_32x32x16_bf16 v[64:79], a[224:227], a[128:131], v[64:79]
    s_waitcnt vmcnt(10)
    v_mfma_f32_32x32x16_bf16 v[64:79], a[232:235], a[136:139], v[64:79]
    s_waitcnt vmcnt(9)
    v_mfma_f32_32x32x16_bf16 v[64:79], a[240:243], a[144:147], v[64:79]
    s_waitcnt vmcnt(8)
    v_mfma_f32_32x32x16_bf16 v[64:79], a[248:251], a[152:155], v[64:79]
    v_mfma_f32_32x32x16_bf16 v[80:95], a[196:199], a[72:75], v[80:95]
    v_mfma_f32_32x32x16_bf16 v[80:95], a[204:207], v[128:131], v[80:95]
    v_mfma_f32_32x32x16_bf16 v[80:95], a[212:215], a[112:115], v[80:95]
    s_nop 8
    ds_write_b128 v34, v[64:67] offset:0
    v_mfma_f32_32x32x16_bf16 v[80:95], a[220:223], a[120:123], v[80:95]
    ds_write_b128 v35, v[68:71] offset:0
    v_mfma_f32_32x32x16_bf16 v[80:95], a[228:231], a[128:131], v[80:95]
    ds_write_b128 v36, v[72:75] offset:0
    v_mfma_f32_32x32x16_bf16 v[80:95], a[236:239], a[136:139], v[80:95]
    ds_write_b128 v37, v[76:79] offset:0
    v_mfma_f32_32x32x16_bf16 v[80:95], a[244:247], a[144:147], v[80:95]
    v_mfma_f32_32x32x16_bf16 v[80:95], a[252:255], a[152:155], v[80:95]
    s_waitcnt vmcnt(7)
    v_mfma_f32_32x32x16_bf16 v[96:111], a[192:195], a[64:67], v[96:111]
    s_waitcnt vmcnt(6)
    v_mfma_f32_32x32x16_bf16 v[96:111], a[200:203], v[168:171], v[96:111]
    s_waitcnt vmcnt(5)
    v_mfma_f32_32x32x16_bf16 v[96:111], a[208:211], a[116:119], v[96:111]
    s_nop 5
    ds_write_b128 v34, v[80:83] offset:128
    ds_write_b128 v35, v[84:87] offset:128
    s_waitcnt vmcnt(4)
    v_mfma_f32_32x32x16_bf16 v[96:111], a[216:219], a[124:127], v[96:111]
    ds_write_b128 v36, v[88:91] offset:128
    s_waitcnt vmcnt(3)
    v_mfma_f32_32x32x16_bf16 v[96:111], a[224:227], a[132:135], v[96:111]
    ds_write_b128 v37, v[92:95] offset:128
    s_waitcnt vmcnt(2)
    v_mfma_f32_32x32x16_bf16 v[96:111], a[232:235], a[140:143], v[96:111]
    s_waitcnt vmcnt(1)
    v_mfma_f32_32x32x16_bf16 v[96:111], a[240:243], a[148:151], v[96:111]
    s_waitcnt lgkmcnt(0)
    s_barrier
    ds_read_b128 v[208:211], v38 offset:0
    ds_read_b128 v[212:215], v39 offset:0
    ds_read_b128 v[216:219], v38 offset:40960
    s_waitcnt vmcnt(0)
    v_mfma_f32_32x32x16_bf16 v[96:111], a[248:251], a[156:159], v[96:111]
    ds_read_b128 v[220:223], v39 offset:40960
    ds_read_b128 v[224:227], v40 offset:0
    ds_read_b128 v[228:231], v41 offset:0
    v_mfma_f32_32x32x16_bf16 v[112:127], a[196:199], a[64:67], v[112:127]
    ds_read_b128 v[232:235], v40 offset:40960
    ds_read_b128 v[236:239], v41 offset:40960
    v_mfma_f32_32x32x16_bf16 v[112:127], a[204:207], v[168:171], v[112:127]
    s_waitcnt lgkmcnt(7)
    v_add_f32 v48, v48, v208
    v_add_f32 v49, v49, v209
    v_add_f32 v50, v50, v210
    v_add_f32 v51, v51, v211
    s_waitcnt lgkmcnt(6)
    v_add_f32 v52, v52, v212
    v_add_f32 v53, v53, v213
    v_add_f32 v54, v54, v214
    v_mfma_f32_32x32x16_bf16 v[112:127], a[212:215], a[116:119], v[112:127]
    ds_write_b128 v34, v[96:99] offset:8192
    ds_write_b128 v35, v[100:103] offset:8192
    v_add_f32 v55, v55, v215
    s_waitcnt lgkmcnt(7)
    v_add_f32 v48, v48, v216
    v_add_f32 v49, v49, v217
    v_add_f32 v50, v50, v218
    v_mfma_f32_32x32x16_bf16 v[112:127], a[220:223], a[124:127], v[112:127]
    ds_write_b128 v36, v[104:107] offset:8192
    v_add_f32 v51, v51, v219
    s_waitcnt lgkmcnt(7)
    v_add_f32 v52, v52, v220
    v_add_f32 v53, v53, v221
    v_add_f32 v54, v54, v222
    v_add_f32 v55, v55, v223
    v_mfma_f32_32x32x16_bf16 v[112:127], a[228:231], a[132:135], v[112:127]
    ds_write_b128 v37, v[108:111] offset:8192
    s_waitcnt lgkmcnt(7)
    v_add_f32 v48, v48, v224
    v_add_f32 v49, v49, v225
    v_add_f32 v50, v50, v226
    v_add_f32 v51, v51, v227
    s_waitcnt lgkmcnt(6)
    v_add_f32 v52, v52, v228
    v_mfma_f32_32x32x16_bf16 v[112:127], a[236:239], a[140:143], v[112:127]
    v_add_f32 v53, v53, v229
    v_add_f32 v54, v54, v230
    v_add_f32 v55, v55, v231
    s_waitcnt lgkmcnt(5)
    v_add_f32 v48, v48, v232
    v_add_f32 v49, v49, v233
    v_add_f32 v50, v50, v234
    v_add_f32 v51, v51, v235
    v_mfma_f32_32x32x16_bf16 v[112:127], a[244:247], a[148:151], v[112:127]
    s_waitcnt lgkmcnt(4)
    v_add_f32 v52, v52, v236
    v_add_f32 v53, v53, v237
    v_add_f32 v54, v54, v238
    v_add_f32 v55, v55, v239
    v_cvt_pk_bf16_f32 v48, v48, v49
    v_cvt_pk_bf16_f32 v49, v50, v51
    v_cvt_pk_bf16_f32 v50, v52, v53
    v_mfma_f32_32x32x16_bf16 v[112:127], a[252:255], a[156:159], v[112:127]
    v_cvt_pk_bf16_f32 v51, v54, v55
    buffer_store_dwordx4 v[48:51], v42, s[28:31], s66 offen sc1
    s_nop 9
    ds_write_b128 v34, v[112:115] offset:8320
    ds_write_b128 v35, v[116:119] offset:8320
    ds_write_b128 v36, v[120:123] offset:8320
    ds_write_b128 v37, v[124:127] offset:8320
    s_waitcnt lgkmcnt(0)
    s_barrier
    ds_read_b128 v[208:211], v38 offset:8192
    ds_read_b128 v[212:215], v39 offset:8192
    ds_read_b128 v[216:219], v38 offset:49152
    ds_read_b128 v[220:223], v39 offset:49152
    ds_read_b128 v[224:227], v40 offset:8192
    ds_read_b128 v[228:231], v41 offset:8192
    ds_read_b128 v[232:235], v40 offset:49152
    ds_read_b128 v[236:239], v41 offset:49152
    s_waitcnt lgkmcnt(7)
    v_pk_add_f32 v[56:57], v[56:57], v[208:209]
    v_pk_add_f32 v[58:59], v[58:59], v[210:211]
    s_waitcnt lgkmcnt(6)
    v_pk_add_f32 v[60:61], v[60:61], v[212:213]
    v_pk_add_f32 v[62:63], v[62:63], v[214:215]
    s_waitcnt lgkmcnt(5)
    v_pk_add_f32 v[56:57], v[56:57], v[216:217]
    v_pk_add_f32 v[58:59], v[58:59], v[218:219]
    s_waitcnt lgkmcnt(4)
    v_pk_add_f32 v[60:61], v[60:61], v[220:221]
    v_pk_add_f32 v[62:63], v[62:63], v[222:223]
    s_waitcnt lgkmcnt(3)
    v_pk_add_f32 v[56:57], v[56:57], v[224:225]
    v_pk_add_f32 v[58:59], v[58:59], v[226:227]
    s_waitcnt lgkmcnt(2)
    v_pk_add_f32 v[60:61], v[60:61], v[228:229]
    v_pk_add_f32 v[62:63], v[62:63], v[230:231]
    s_waitcnt lgkmcnt(1)
    v_pk_add_f32 v[56:57], v[56:57], v[232:233]
    v_pk_add_f32 v[58:59], v[58:59], v[234:235]
    s_waitcnt lgkmcnt(0)
    v_pk_add_f32 v[60:61], v[60:61], v[236:237]
    v_pk_add_f32 v[62:63], v[62:63], v[238:239]
    v_cvt_pk_bf16_f32 v56, v56, v57
    v_cvt_pk_bf16_f32 v57, v58, v59
    v_cvt_pk_bf16_f32 v58, v60, v61
    v_cvt_pk_bf16_f32 v59, v62, v63
    s_add_u32 s40, s66, 32768
    buffer_store_dwordx4 v[56:59], v42, s[28:31], s40 offen sc1
    s_endpgm
Lpub_2e:
    s_and_b32 s41, s2, 15
    s_lshl2_add_u32 s41, s41, s38
    s_lshl_b32 s41, s41, 2
    v_mov_b32 v25, 1
    v_mov_b32 v26, s41
    s_mov_b64 exec, 1
    global_store_dword v26, v25, s[36:37] sc1
    s_mov_b64 exec, -1
    s_branch Lpub_2
Lretry_4e:
    s_mov_b32 s3, 0
Lretry_4:
    global_load_dword v25, v26, s[36:37] sc1
    s_add_u32 s3, s3, 1
    s_cmp_gt_u32 s3, 400000
    s_cbranch_scc1 Lok_3
    s_waitcnt vmcnt(0)
    v_cmp_gt_u32 vcc, 1, v25
    s_nop 1
    s_cbranch_vccnz Lretry_4
    s_branch Lok_3
Lretry_6e:
    s_mov_b32 s3, 0
Lretry_6:
    buffer_load_dword v25, v26, s[24:27], 0 offen sc1
    s_add_u32 s3, s3, 1
    s_cmp_gt_u32 s3, 400000
    s_cbranch_scc1 Lok_5
    s_waitcnt vmcnt(0)
    v_cmp_gt_u32 vcc, 1, v25
    s_nop 1
    s_cbranch_vccnz Lretry_6
    s_branch Lok_5
Lretry_24e:
    s_mov_b32 s3, 0
Lretry_24:
    buffer_load_dword v25, v26, s[24:27], 0 offen sc1
    s_add_u32 s3, s3, 1
    s_cmp_gt_u32 s3, 400000
    s_cbranch_scc1 Lok_23
    s_waitcnt vmcnt(0)
    v_cmp_gt_u32 vcc, 1, v25
    s_nop 1
    s_cbranch_vccnz Lretry_24
    s_branch Lok_23
Lretry_26e:
    s_mov_b32 s3, 0
Lretry_26:
    buffer_load_dword v25, v26, s[24:27], 0 offen sc1
    s_add_u32 s3, s3, 1
    s_cmp_gt_u32 s3, 400000
    s_cbranch_scc1 Lok_25
    s_waitcnt vmcnt(0)
    v_cmp_gt_u32 vcc, 1, v25
    s_nop 1
    s_cbranch_vccnz Lretry_26
    s_branch Lok_25
Lretry_28e:
    s_mov_b32 s3, 0
Lretry_28:
    buffer_load_dword v25, v26, s[24:27], 0 offen sc1
    s_add_u32 s3, s3, 1
    s_cmp_gt_u32 s3, 400000
    s_cbranch_scc1 Lok_27
    s_waitcnt vmcnt(0)
    v_cmp_gt_u32 vcc, 1, v25
    s_nop 1
    s_cbranch_vccnz Lretry_28
    s_branch Lok_27
Lhot:
Lx_7o:
    s_cmp_lt_u32 s62, 4
    s_cbranch_scc1 Lx_7e
    s_waitcnt vmcnt(0) lgkmcnt(0)
    s_nop 15
    v_mfma_f32_32x32x16_bf16 v[208:223], a[72:75], a[64:67], 0
    v_mfma_f32_32x32x16_bf16 v[224:239], a[104:107], a[64:67], 0
    s_nop 11
    v_cndmask_b32 v96, v208, v224, s[68:69]
    v_cndmask_b32 v97, v209, v225, s[70:71]
    v_cndmask_b32 v98, v210, v226, s[72:73]
    v_cndmask_b32 v99, v211, v227, s[74:75]
    v_cndmask_b32 v100, v212, v228, s[76:77]
    v_cndmask_b32 v101, v213, v229, s[78:79]
    v_cndmask_b32 v102, v214, v230, s[80:81]
    v_cndmask_b32 v103, v215, v231, s[82:83]
    v_cndmask_b32 v104, v216, v232, s[84:85]
    v_cndmask_b32 v105, v217, v233, s[86:87]
    v_cndmask_b32 v106, v218, v234, s[88:89]
    v_cndmask_b32 v107, v219, v235, s[90:91]
    v_cndmask_b32 v108, v220, v236, s[92:93]
    v_cndmask_b32 v109, v221, v237, s[94:95]
    v_cndmask_b32 v110, v222, v238, s[96:97]
    v_cndmask_b32 v111, v223, v239, s[98:99]
    v_max_f32 v2, v96, v97
    v_max3_f32 v2, v2, v98, v99
    v_max3_f32 v2, v2, v100, v101
    v_max3_f32 v2, v2, v102, v103
    v_max3_f32 v2, v2, v104, v105
    v_max3_f32 v2, v2, v106, v107
    v_max3_f32 v2, v2, v108, v109
    v_max3_f32 v2, v2, v110, v111
    v_mfma_f32_32x32x16_bf16 v[208:223], a[100:103], a[64:67], 0
    s_nop 11
    v_max3_f32 v2, v2, v208, v209
    v_max3_f32 v2, v2, v210, v211
    v_max3_f32 v2, v2, v212, v213
    v_max3_f32 v2, v2, v214, v215
    v_max3_f32 v2, v2, v216, v217
    v_max3_f32 v2, v2, v218, v219
    v_max3_f32 v2, v2, v220, v221
    v_max3_f32 v2, v2, v222, v223
    v_mfma_f32_32x32x16_bf16 v[208:223], a[96:99], a[64:67], 0
    s_nop 11
    v_max3_f32 v2, v2, v208, v209
    v_max3_f32 v2, v2, v210, v211
    v_max3_f32 v2, v2, v212, v213
    v_max3_f32 v2, v2, v214, v215
    v_max3_f32 v2, v2, v216, v217
    v_max3_f32 v2, v2, v218, v219
    v_max3_f32 v2, v2, v220, v221
    v_max3_f32 v2, v2, v222, v223
    v_mfma_f32_32x32x16_bf16 v[208:223], a[92:95], a[64:67], 0
    s_nop 11
    v_max3_f32 v2, v2, v208, v209
    v_max3_f32 v2, v2, v210, v211
    v_max3_f32 v2, v2, v212, v213
    v_max3_f32 v2, v2, v214, v215
    v_max3_f32 v2, v2, v216, v217
    v_max3_f32 v2, v2, v218, v219
    v_max3_f32 v2, v2, v220, v221
    v_max3_f32 v2, v2, v222, v223
    v_mfma_f32_32x32x16_bf16 v[208:223], a[88:91], a[64:67], 0
    s_nop 11
    v_max3_f32 v2, v2, v208, v209
    v_max3_f32 v2, v2, v210, v211
    v_max3_f32 v2, v2, v212, v213
    v_max3_f32 v2, v2, v214, v215
    v_max3_f32 v2, v2, v216, v217
    v_max3_f32 v2, v2, v218, v219
    v_max3_f32 v2, v2, v220, v221
    v_max3_f32 v2, v2, v222, v223
    v_mfma_f32_32x32x16_bf16 v[208:223], a[84:87], a[64:67], 0
    s_nop 11
    v_max3_f32 v2, v2, v208, v209
    v_max3_f32 v2, v2, v210, v211
    v_max3_f32 v2, v2, v212, v213
    v_max3_f32 v2, v2, v214, v215
    v_max3_f32 v2, v2, v216, v217
    v_max3_f32 v2, v2, v218, v219
    v_max3_f32 v2, v2, v220, v221
    v_max3_f32 v2, v2, v222, v223
    v_mfma_f32_32x32x16_bf16 v[208:223], a[80:83], a[64:67], 0
    s_nop 11
    v_max3_f32 v2, v2, v208, v209
    v_max3_f32 v2, v2, v210, v211
    v_max3_f32 v2, v2, v212, v213
    v_max3_f32 v2, v2, v214, v215
    v_max3_f32 v2, v2, v216, v217
    v_max3_f32 v2, v2, v218, v219
    v_max3_f32 v2, v2, v220, v221
    v_max3_f32 v2, v2, v222, v223
    v_mfma_f32_32x32x16_bf16 v[208:223], a[76:79], a[64:67], 0
    s_nop 11
    v_max3_f32 v2, v2, v208, v209
    v_max3_f32 v2, v2, v210, v211
    v_max3_f32 v2, v2, v212, v213
    v_max3_f32 v2, v2, v214, v215
    v_max3_f32 v2, v2, v216, v217
    v_max3_f32 v2, v2, v218, v219
    v_max3_f32 v2, v2, v220, v221
    v_max3_f32 v2, v2, v222, v223
    v_mov_b32 v3, v2
    s_nop 1
    v_permlane32_swap_b32 v2, v3
    v_max_f32 v2, v2, v3
    v_sub_f32 v64, 0, v2
    v_sub_f32 v65, 0, v2
    v_sub_f32 v66, 0, v2
    v_sub_f32 v67, 0, v2
    v_sub_f32 v68, 0, v2
    v_sub_f32 v69, 0, v2
    v_sub_f32 v70, 0, v2
    v_sub_f32 v71, 0, v2
    v_sub_f32 v72, 0, v2
    v_sub_f32 v73, 0, v2
    v_sub_f32 v74, 0, v2
    v_sub_f32 v75, 0, v2
    v_sub_f32 v76, 0, v2
    v_sub_f32 v77, 0, v2
    v_sub_f32 v78, 0, v2
    v_sub_f32 v79, 0, v2
    v_sub_f32 v96, v96, v2
    v_sub_f32 v97, v97, v2
    v_sub_f32 v98, v98, v2
    v_sub_f32 v99, v99, v2
    v_sub_f32 v100, v100, v2
    v_sub_f32 v101, v101, v2
    v_sub_f32 v102, v102, v2
    v_sub_f32 v103, v103, v2
    v_sub_f32 v104, v104, v2
    v_sub_f32 v105, v105, v2
    v_sub_f32 v106, v106, v2
    v_sub_f32 v107, v107, v2
    v_sub_f32 v108, v108, v2
    v_sub_f32 v109, v109, v2
    v_sub_f32 v110, v110, v2
    v_sub_f32 v111, v111, v2
    v_exp_f32 v96, v96
    v_exp_f32 v97, v97
    v_exp_f32 v98, v98
    v_exp_f32 v99, v99
    v_cvt_pk_bf16_f32 v112, v96, v97
    v_exp_f32 v100, v100
    v_exp_f32 v101, v101
    v_cvt_pk_bf16_f32 v113, v98, v99
    v_exp_f32 v102, v102
    v_exp_f32 v103, v103
    v_cvt_pk_bf16_f32 v114, v100, v101
    v_exp_f32 v104, v104
    v_exp_f32 v105, v105
    v_cvt_pk_bf16_f32 v115, v102, v103
    v_exp_f32 v106, v106
    v_exp_f32 v107, v107
    v_cvt_pk_bf16_f32 v116, v104, v105
    v_exp_f32 v108, v108
    v_exp_f32 v109, v109
    v_cvt_pk_bf16_f32 v117, v106, v107
    v_exp_f32 v110, v110
    v_exp_f32 v111, v111
    v_cvt_pk_bf16_f32 v118, v108, v109
    v_cvt_pk_bf16_f32 v119, v110, v111
    v_bfi_b32 v48, v56, 0, v112
    v_and_b32 v112, v56, v112
    v_bfi_b32 v49, v57, 0, v113
    v_and_b32 v113, v57, v113
    v_bfi_b32 v50, v58, 0, v114
    v_and_b32 v114, v58, v114
    v_bfi_b32 v51, v59, 0, v115
    v_and_b32 v115, v59, v115
    v_bfi_b32 v52, v60, 0, v116
    v_and_b32 v116, v60, v116
    v_bfi_b32 v53, v61, 0, v117
    v_and_b32 v117, v61, v117
    v_bfi_b32 v54, v62, 0, v118
    v_and_b32 v118, v62, v118
    v_bfi_b32 v55, v63, 0, v119
    v_and_b32 v119, v63, v119
    v_mfma_f32_32x32x16_bf16 v[80:95], v[160:163], v[112:115], 0
    s_nop 0
    v_mfma_f32_32x32x16_bf16 v[80:95], v[200:203], v[116:119], v[80:95]
    v_mfma_f32_32x32x16_bf16 v[80:95], v[128:131], v[48:51], v[80:95]
    v_mfma_f32_32x32x16_bf16 v[80:95], v[168:171], v[52:55], v[80:95]
    v_mfma_f32_32x32x16_bf16 v[208:223], a[100:103], a[64:67], v[64:79]
    s_nop 11
    v_exp_f32 v208, v208
    v_exp_f32 v209, v209
    v_exp_f32 v210, v210
    v_exp_f32 v211, v211
    v_cvt_pk_bf16_f32 v112, v208, v209
    v_exp_f32 v212, v212
    v_exp_f32 v213, v213
    v_cvt_pk_bf16_f32 v113, v210, v211
    v_exp_f32 v214, v214
    v_exp_f32 v215, v215
    v_cvt_pk_bf16_f32 v114, v212, v213
    v_exp_f32 v216, v216
    v_exp_f32 v217, v217
    v_cvt_pk_bf16_f32 v115, v214, v215
    v_exp_f32 v218, v218
    v_exp_f32 v219, v219
    v_cvt_pk_bf16_f32 v116, v216, v217
    v_exp_f32 v220, v220
    v_exp_f32 v221, v221
    v_cvt_pk_bf16_f32 v117, v218, v219
    v_exp_f32 v222, v222
    v_exp_f32 v223, v223
    v_cvt_pk_bf16_f32 v118, v220, v221
    v_cvt_pk_bf16_f32 v119, v222, v223
    v_mfma_f32_32x32x16_bf16 v[80:95], v[156:159], v[112:115], v[80:95]
    s_nop 0
    v_mfma_f32_32x32x16_bf16 v[80:95], v[196:199], v[116:119], v[80:95]
    v_mfma_f32_32x32x16_bf16 v[208:223], a[96:99], a[64:67], v[64:79]
    s_nop 11
    v_exp_f32 v208, v208
    v_exp_f32 v209, v209
    v_exp_f32 v210, v210
    v_exp_f32 v211, v211
    v_cvt_pk_bf16_f32 v112, v208, v209
    v_exp_f32 v212, v212
    v_exp_f32 v213, v213
    v_cvt_pk_bf16_f32 v113, v210, v211
    v_exp_f32 v214, v214
    v_exp_f32 v215, v215
    v_cvt_pk_bf16_f32 v114, v212, v213
    v_exp_f32 v216, v216
    v_exp_f32 v217, v217
    v_cvt_pk_bf16_f32 v115, v214, v215
    v_exp_f32 v218, v218
    v_exp_f32 v219, v219
    v_cvt_pk_bf16_f32 v116, v216, v217
    v_exp_f32 v220, v220
    v_exp_f32 v221, v221
    v_cvt_pk_bf16_f32 v117, v218, v219
    v_exp_f32 v222, v222
    v_exp_f32 v223, v223
    v_cvt_pk_bf16_f32 v118, v220, v221
    v_cvt_pk_bf16_f32 v119, v222, v223
    v_mfma_f32_32x32x16_bf16 v[80:95], v[152:155], v[112:115], v[80:95]
    s_nop 0
    v_mfma_f32_32x32x16_bf16 v[80:95], v[192:195], v[116:119], v[80:95]
    v_mfma_f32_32x32x16_bf16 v[208:223], a[92:95], a[64:67], v[64:79]
    s_nop 11
    v_exp_f32 v208, v208
    v_exp_f32 v209, v209
    v_exp_f32 v210, v210
    v_exp_f32 v211, v211
    v_cvt_pk_bf16_f32 v112, v208, v209
    v_exp_f32 v212, v212
    v_exp_f32 v213, v213
    v_cvt_pk_bf16_f32 v113, v210, v211
    v_exp_f32 v214, v214
    v_exp_f32 v215, v215
    v_cvt_pk_bf16_f32 v114, v212, v213
    v_exp_f32 v216, v216
    v_exp_f32 v217, v217
    v_cvt_pk_bf16_f32 v115, v214, v215
    v_exp_f32 v218, v218
    v_exp_f32 v219, v219
    v_cvt_pk_bf16_f32 v116, v216, v217
    v_exp_f32 v220, v220
    v_exp_f32 v221, v221
    v_cvt_pk_bf16_f32 v117, v218, v219
    v_exp_f32 v222, v222
    v_exp_f32 v223, v223
    v_cvt_pk_bf16_f32 v118, v220, v221
    v_cvt_pk_bf16_f32 v119, v222, v223
    v_mfma_f32_32x32x16_bf16 v[80:95], v[148:151], v[112:115], v[80:95]
    s_nop 0
    v_mfma_f32_32x32x16_bf16 v[80:95], v[188:191], v[116:119], v[80:95]
    v_mfma_f32_32x32x16_bf16 v[208:223], a[88:91], a[64:67], v[64:79]
    s_nop 11
    v_exp_f32 v208, v208
    v_exp_f32 v209, v209
    v_exp_f32 v210, v210
    v_exp_f32 v211, v211
    v_cvt_pk_bf16_f32 v112, v208, v209
    v_exp_f32 v212, v212
    v_exp_f32 v213, v213
    v_cvt_pk_bf16_f32 v113, v210, v211
    v_exp_f32 v214, v214
    v_exp_f32 v215, v215
    v_cvt_pk_bf16_f32 v114, v212, v213
    v_exp_f32 v216, v216
    v_exp_f32 v217, v217
    v_cvt_pk_bf16_f32 v115, v214, v215
    v_exp_f32 v218, v218
    v_exp_f32 v219, v219
    v_cvt_pk_bf16_f32 v116, v216, v217
    v_exp_f32 v220, v220
    v_exp_f32 v221, v221
    v_cvt_pk_bf16_f32 v117, v218, v219
    v_exp_f32 v222, v222
    v_exp_f32 v223, v223
    v_cvt_pk_bf16_f32 v118, v220, v221
    v_cvt_pk_bf16_f32 v119, v222, v223
    v_mfma_f32_32x32x16_bf16 v[80:95], v[144:147], v[112:115], v[80:95]
    s_nop 0
    v_mfma_f32_32x32x16_bf16 v[80:95], v[184:187], v[116:119], v[80:95]
    v_mfma_f32_32x32x16_bf16 v[208:223], a[84:87], a[64:67], v[64:79]
    s_nop 11
    v_exp_f32 v208, v208
    v_exp_f32 v209, v209
    v_exp_f32 v210, v210
    v_exp_f32 v211, v211
    v_cvt_pk_bf16_f32 v112, v208, v209
    v_exp_f32 v212, v212
    v_exp_f32 v213, v213
    v_cvt_pk_bf16_f32 v113, v210, v211
    v_exp_f32 v214, v214
    v_exp_f32 v215, v215
    v_cvt_pk_bf16_f32 v114, v212, v213
    v_exp_f32 v216, v216
    v_exp_f32 v217, v217
    v_cvt_pk_bf16_f32 v115, v214, v215
    v_exp_f32 v218, v218
    v_exp_f32 v219, v219
    v_cvt_pk_bf16_f32 v116, v216, v217
    v_exp_f32 v220, v220
    v_exp_f32 v221, v221
    v_cvt_pk_bf16_f32 v117, v218, v219
    v_exp_f32 v222, v222
    v_exp_f32 v223, v223
    v_cvt_pk_bf16_f32 v118, v220, v221
    v_cvt_pk_bf16_f32 v119, v222, v223
    v_mfma_f32_32x32x16_bf16 v[80:95], v[140:143], v[112:115], v[80:95]
    s_nop 0
    v_mfma_f32_32x32x16_bf16 v[80:95], v[180:183], v[116:119], v[80:95]
    v_mfma_f32_32x32x16_bf16 v[208:223], a[80:83], a[64:67], v[64:79]
    s_nop 11
    v_exp_f32 v208, v208
    v_exp_f32 v209, v209
    v_exp_f32 v210, v210
    v_exp_f32 v211, v211
    v_cvt_pk_bf16_f32 v112, v208, v209
    v_exp_f32 v212, v212
    v_exp_f32 v213, v213
    v_cvt_pk_bf16_f32 v113, v210, v211
    v_exp_f32 v214, v214
    v_exp_f32 v215, v215
    v_cvt_pk_bf16_f32 v114, v212, v213
    v_exp_f32 v216, v216
    v_exp_f32 v217, v217
    v_cvt_pk_bf16_f32 v115, v214, v215
    v_exp_f32 v218, v218
    v_exp_f32 v219, v219
    v_cvt_pk_bf16_f32 v116, v216, v217
    v_exp_f32 v220, v220
    v_exp_f32 v221, v221
    v_cvt_pk_bf16_f32 v117, v218, v219
    v_exp_f32 v222, v222
    v_exp_f32 v223, v223
    v_cvt_pk_bf16_f32 v118, v220, v221
    v_cvt_pk_bf16_f32 v119, v222, v223
    v_mfma_f32_32x32x16_bf16 v[80:95], v[136:139], v[112:115], v[80:95]
    s_nop 0
    v_mfma_f32_32x32x16_bf16 v[80:95], v[176:179], v[116:119], v[80:95]
    v_mfma_f32_32x32x16_bf16 v[208:223], a[76:79], a[64:67], v[64:79]
    s_nop 11
    v_exp_f32 v208, v208
    v_exp_f32 v209, v209
    v_exp_f32 v210, v210
    v_exp_f32 v211, v211
    v_cvt_pk_bf16_f32 v112, v208, v209
    v_exp_f32 v212, v212
    v_exp_f32 v213, v213
    v_cvt_pk_bf16_f32 v113, v210, v211
    v_exp_f32 v214, v214
    v_exp_f32 v215, v215
    v_cvt_pk_bf16_f32 v114, v212, v213
    v_exp_f32 v216, v216
    v_exp_f32 v217, v217
    v_cvt_pk_bf16_f32 v115, v214, v215
    v_exp_f32 v218, v218
    v_exp_f32 v219, v219
    v_cvt_pk_bf16_f32 v116, v216, v217
    v_exp_f32 v220, v220
    v_exp_f32 v221, v221
    v_cvt_pk_bf16_f32 v117, v218, v219
    v_exp_f32 v222, v222
    v_exp_f32 v223, v223
    v_cvt_pk_bf16_f32 v118, v220, v221
    v_cvt_pk_bf16_f32 v119, v222, v223
    v_mfma_f32_32x32x16_bf16 v[80:95], v[132:135], v[112:115], v[80:95]
    s_nop 0
    v_mfma_f32_32x32x16_bf16 v[80:95], v[172:175], v[116:119], v[80:95]
    v_mfma_f32_32x32x16_bf16 v[208:223], a[76:79], a[68:71], 0
    v_mfma_f32_32x32x16_bf16 v[224:239], a[108:111], a[68:71], 0
    s_nop 11
    v_cndmask_b32 v224, v208, v224, s[68:69]
    v_cndmask_b32 v225, v209, v225, s[70:71]
    v_cndmask_b32 v226, v210, v226, s[72:73]
    v_cndmask_b32 v227, v211, v227, s[74:75]
    v_cndmask_b32 v228, v212, v228, s[76:77]
    v_cndmask_b32 v229, v213, v229, s[78:79]
    v_cndmask_b32 v230, v214, v230, s[80:81]
    v_cndmask_b32 v231, v215, v231, s[82:83]
    v_cndmask_b32 v232, v216, v232, s[84:85]
    v_cndmask_b32 v233, v217, v233, s[86:87]
    v_cndmask_b32 v234, v218, v234, s[88:89]
    v_cndmask_b32 v235, v219, v235, s[90:91]
    v_cndmask_b32 v236, v220, v236, s[92:93]
    v_cndmask_b32 v237, v221, v237, s[94:95]
    v_cndmask_b32 v238, v222, v238, s[96:97]
    v_cndmask_b32 v239, v223, v239, s[98:99]
    s_nop 15
    s_branch Lx_7
Lx_7e:
    s_waitcnt vmcnt(0) lgkmcnt(0)
    s_nop 15
    v_mov_b64 v[64:65], 0
    v_mov_b64 v[66:67], 0
    v_mov_b64 v[68:69], 0
    v_mov_b64 v[70:71], 0
    v_mov_b64 v[72:73], 0
    v_mov_b64 v[74:75], 0
    v_mov_b64 v[76:77], 0
    v_mov_b64 v[78:79], 0
    v_mfma_f32_32x32x16_bf16 v[224:239], a[104:107], a[64:67], 0
    s_nop 11
    v_cndmask_b32 v96, v4, v224, s[68:69]
    v_cndmask_b32 v97, v4, v225, s[70:71]
    v_cndmask_b32 v98, v4, v226, s[72:73]
    v_cndmask_b32 v99, v4, v227, s[74:75]
    v_cndmask_b32 v100, v4, v228, s[76:77]
    v_cndmask_b32 v101, v4, v229, s[78:79]
    v_cndmask_b32 v102, v4, v230, s[80:81]
    v_cndmask_b32 v103, v4, v231, s[82:83]
    v_cndmask_b32 v104, v4, v232, s[84:85]
    v_cndmask_b32 v105, v4, v233, s[86:87]
    v_cndmask_b32 v106, v4, v234, s[88:89]
    v_cndmask_b32 v107, v4, v235, s[90:91]
    v_cndmask_b32 v108, v4, v236, s[92:93]
    v_cndmask_b32 v109, v4, v237, s[94:95]
    v_cndmask_b32 v110, v4, v238, s[96:97]
    v_cndmask_b32 v111, v4, v239, s[98:99]
    v_max_f32 v2, v96, v97
    v_max3_f32 v2, v2, v98, v99
    v_max3_f32 v2, v2, v100, v101
    v_max3_f32 v2, v2, v102, v103
    v_max3_f32 v2, v2, v104, v105
    v_max3_f32 v2, v2, v106, v107
    v_max3_f32 v2, v2, v108, v109
    v_max3_f32 v2, v2, v110, v111
    s_cmp_eq_u32 s62, 0
    s_cbranch_scc1 Lc_8o
Lc_8:
    v_mfma_f32_32x32x16_bf16 v[208:223], a[100:103], a[64:67], v[64:79]
    s_nop 11
    v_max3_f32 v2, v2, v208, v209
    v_max3_f32 v2, v2, v210, v211
    v_max3_f32 v2, v2, v212, v213
    v_max3_f32 v2, v2, v214, v215
    v_max3_f32 v2, v2, v216, v217
    v_max3_f32 v2, v2, v218, v219
    v_max3_f32 v2, v2, v220, v221
    v_max3_f32 v2, v2, v222, v223
    v_mfma_f32_32x32x16_bf16 v[208:223], a[96:99], a[64:67], v[64:79]
    s_nop 11
    v_max3_f32 v2, v2, v208, v209
    v_max3_f32 v2, v2, v210, v211
    v_max3_f32 v2, v2, v212, v213
    v_max3_f32 v2, v2, v214, v215
    v_max3_f32 v2, v2, v216, v217
    v_max3_f32 v2, v2, v218, v219
    v_max3_f32 v2, v2, v220, v221
    v_max3_f32 v2, v2, v222, v223
    s_cmp_eq_u32 s62, 1
    s_cbranch_scc1 Lc_9o
Lc_9:
    v_mfma_f32_32x32x16_bf16 v[208:223], a[92:95], a[64:67], v[64:79]
    s_nop 11
    v_max3_f32 v2, v2, v208, v209
    v_max3_f32 v2, v2, v210, v211
    v_max3_f32 v2, v2, v212, v213
    v_max3_f32 v2, v2, v214, v215
    v_max3_f32 v2, v2, v216, v217
    v_max3_f32 v2, v2, v218, v219
    v_max3_f32 v2, v2, v220, v221
    v_max3_f32 v2, v2, v222, v223
    v_mfma_f32_32x32x16_bf16 v[208:223], a[88:91], a[64:67], v[64:79]
    s_nop 11
    v_max3_f32 v2, v2, v208, v209
    v_max3_f32 v2, v2, v210, v211
    v_max3_f32 v2, v2, v212, v213
    v_max3_f32 v2, v2, v214, v215
    v_max3_f32 v2, v2, v216, v217
    v_max3_f32 v2, v2, v218, v219
    v_max3_f32 v2, v2, v220, v221
    v_max3_f32 v2, v2, v222, v223
    s_cmp_eq_u32 s62, 2
    s_cbranch_scc1 Lc_10o
Lc_10:
    v_mfma_f32_32x32x16_bf16 v[208:223], a[84:87], a[64:67], v[64:79]
    s_nop 11
    v_max3_f32 v2, v2, v208, v209
    v_max3_f32 v2, v2, v210, v211
    v_max3_f32 v2, v2, v212, v213
    v_max3_f32 v2, v2, v214, v215
    v_max3_f32 v2, v2, v216, v217
    v_max3_f32 v2, v2, v218, v219
    v_max3_f32 v2, v2, v220, v221
    v_max3_f32 v2, v2, v222, v223
    v_mfma_f32_32x32x16_bf16 v[208:223], a[80:83], a[64:67], v[64:79]
    s_nop 11
    v_max3_f32 v2, v2, v208, v209
    v_max3_f32 v2, v2, v210, v211
    v_max3_f32 v2, v2, v212, v213
    v_max3_f32 v2, v2, v214, v215
    v_max3_f32 v2, v2, v216, v217
    v_max3_f32 v2, v2, v218, v219
    v_max3_f32 v2, v2, v220, v221
    v_max3_f32 v2, v2, v222, v223
    s_cmp_eq_u32 s62, 3
    s_cbranch_scc1 Lc_11o
Lc_11:
    v_mfma_f32_32x32x16_bf16 v[208:223], a[76:79], a[64:67], v[64:79]
    s_nop 11
    v_max3_f32 v2, v2, v208, v209
    v_max3_f32 v2, v2, v210, v211
    v_max3_f32 v2, v2, v212, v213
    v_max3_f32 v2, v2, v214, v215
    v_max3_f32 v2, v2, v216, v217
    v_max3_f32 v2, v2, v218, v219
    v_max3_f32 v2, v2, v220, v221
    v_max3_f32 v2, v2, v222, v223
    v_mov_b32 v3, v2
    s_nop 1
    v_permlane32_swap_b32 v2, v3
    v_max_f32 v2, v2, v3
    v_sub_f32 v64, 0, v2
    v_sub_f32 v65, 0, v2
    v_sub_f32 v66, 0, v2
    v_sub_f32 v67, 0, v2
    v_sub_f32 v68, 0, v2
    v_sub_f32 v69, 0, v2
    v_sub_f32 v70, 0, v2
    v_sub_f32 v71, 0, v2
    v_sub_f32 v72, 0, v2
    v_sub_f32 v73, 0, v2
    v_sub_f32 v74, 0, v2
    v_sub_f32 v75, 0, v2
    v_sub_f32 v76, 0, v2
    v_sub_f32 v77, 0, v2
    v_sub_f32 v78, 0, v2
    v_sub_f32 v79, 0, v2
    v_sub_f32 v96, v96, v2
    v_sub_f32 v97, v97, v2
    v_sub_f32 v98, v98, v2
    v_sub_f32 v99, v99, v2
    v_sub_f32 v100, v100, v2
    v_sub_f32 v101, v101, v2
    v_sub_f32 v102, v102, v2
    v_sub_f32 v103, v103, v2
    v_sub_f32 v104, v104, v2
    v_sub_f32 v105, v105, v2
    v_sub_f32 v106, v106, v2
    v_sub_f32 v107, v107, v2
    v_sub_f32 v108, v108, v2
    v_sub_f32 v109, v109, v2
    v_sub_f32 v110, v110, v2
    v_sub_f32 v111, v111, v2
    v_exp_f32 v96, v96
    v_exp_f32 v97, v97
    v_exp_f32 v98, v98
    v_exp_f32 v99, v99
    v_cvt_pk_bf16_f32 v112, v96, v97
    v_exp_f32 v100, v100
    v_exp_f32 v101, v101
    v_cvt_pk_bf16_f32 v113, v98, v99
    v_exp_f32 v102, v102
    v_exp_f32 v103, v103
    v_cvt_pk_bf16_f32 v114, v100, v101
    v_exp_f32 v104, v104
    v_exp_f32 v105, v105
    v_cvt_pk_bf16_f32 v115, v102, v103
    v_exp_f32 v106, v106
    v_exp_f32 v107, v107
    v_cvt_pk_bf16_f32 v116, v104, v105
    v_exp_f32 v108, v108
    v_exp_f32 v109, v109
    v_cvt_pk_bf16_f32 v117, v106, v107
    v_exp_f32 v110, v110
    v_exp_f32 v111, v111
    v_cvt_pk_bf16_f32 v118, v108, v109
    v_cvt_pk_bf16_f32 v119, v110, v111
    v_mfma_f32_32x32x16_bf16 v[80:95], v[160:163], v[112:115], 0
    s_nop 0
    v_mfma_f32_32x32x16_bf16 v[80:95], v[200:203], v[116:119], v[80:95]
    s_cmp_eq_u32 s62, 0
    s_cbranch_scc1 Lc_12o
Lc_12:
    v_mfma_f32_32x32x16_bf16 v[208:223], a[100:103], a[64:67], v[64:79]
    s_nop 11
    v_exp_f32 v208, v208
    v_exp_f32 v209, v209
    v_exp_f32 v210, v210
    v_exp_f32 v211, v211
    v_cvt_pk_bf16_f32 v112, v208, v209
    v_exp_f32 v212, v212
    v_exp_f32 v213, v213
    v_cvt_pk_bf16_f32 v113, v210, v211
    v_exp_f32 v214, v214
    v_exp_f32 v215, v215
    v_cvt_pk_bf16_f32 v114, v212, v213
    v_exp_f32 v216, v216
    v_exp_f32 v217, v217
    v_cvt_pk_bf16_f32 v115, v214, v215
    v_exp_f32 v218, v218
    v_exp_f32 v219, v219
    v_cvt_pk_bf16_f32 v116, v216, v217
    v_exp_f32 v220, v220
    v_exp_f32 v221, v221
    v_cvt_pk_bf16_f32 v117, v218, v219
    v_exp_f32 v222, v222
    v_exp_f32 v223, v223
    v_cvt_pk_bf16_f32 v118, v220, v221
    v_cvt_pk_bf16_f32 v119, v222, v223
    v_mfma_f32_32x32x16_bf16 v[80:95], v[156:159], v[112:115], v[80:95]
    s_nop 0
    v_mfma_f32_32x32x16_bf16 v[80:95], v[196:199], v[116:119], v[80:95]
    v_mfma_f32_32x32x16_bf16 v[208:223], a[96:99], a[64:67], v[64:79]
    s_nop 11
    v_exp_f32 v208, v208
    v_exp_f32 v209, v209
    v_exp_f32 v210, v210
    v_exp_f32 v211, v211
    v_cvt_pk_bf16_f32 v112, v208, v209
    v_exp_f32 v212, v212
    v_exp_f32 v213, v213
    v_cvt_pk_bf16_f32 v113, v210, v211
    v_exp_f32 v214, v214
    v_exp_f32 v215, v215
    v_cvt_pk_bf16_f32 v114, v212, v213
    v_exp_f32 v216, v216
    v_exp_f32 v217, v217
    v_cvt_pk_bf16_f32 v115, v214, v215
    v_exp_f32 v218, v218
    v_exp_f32 v219, v219
    v_cvt_pk_bf16_f32 v116, v216, v217
    v_exp_f32 v220, v220
    v_exp_f32 v221, v221
    v_cvt_pk_bf16_f32 v117, v218, v219
    v_exp_f32 v222, v222
    v_exp_f32 v223, v223
    v_cvt_pk_bf16_f32 v118, v220, v221
    v_cvt_pk_bf16_f32 v119, v222, v223
    v_mfma_f32_32x32x16_bf16 v[80:95], v[152:155], v[112:115], v[80:95]
    s_nop 0
    v_mfma_f32_32x32x16_bf16 v[80:95], v[192:195], v[116:119], v[80:95]
    s_cmp_eq_u32 s62, 1
    s_cbranch_scc1 Lc_13o
Lc_13:
    v_mfma_f32_32x32x16_bf16 v[208:223], a[92:95], a[64:67], v[64:79]
    s_nop 11
    v_exp_f32 v208, v208
    v_exp_f32 v209, v209
    v_exp_f32 v210, v210
    v_exp_f32 v211, v211
    v_cvt_pk_bf16_f32 v112, v208, v209
    v_exp_f32 v212, v212
    v_exp_f32 v213, v213
    v_cvt_pk_bf16_f32 v113, v210, v211
    v_exp_f32 v214, v214
    v_exp_f32 v215, v215
    v_cvt_pk_bf16_f32 v114, v212, v213
    v_exp_f32 v216, v216
    v_exp_f32 v217, v217
    v_cvt_pk_bf16_f32 v115, v214, v215
    v_exp_f32 v218, v218
    v_exp_f32 v219, v219
    v_cvt_pk_bf16_f32 v116, v216, v217
    v_exp_f32 v220, v220
    v_exp_f32 v221, v221
    v_cvt_pk_bf16_f32 v117, v218, v219
    v_exp_f32 v222, v222
    v_exp_f32 v223, v223
    v_cvt_pk_bf16_f32 v118, v220, v221
    v_cvt_pk_bf16_f32 v119, v222, v223
    v_mfma_f32_32x32x16_bf16 v[80:95], v[148:151], v[112:115], v[80:95]
    s_nop 0
    v_mfma_f32_32x32x16_bf16 v[80:95], v[188:191], v[116:119], v[80:95]
    v_mfma_f32_32x32x16_bf16 v[208:223], a[88:91], a[64:67], v[64:79]
    s_nop 11
    v_exp_f32 v208, v208
    v_exp_f32 v209, v209
    v_exp_f32 v210, v210
    v_exp_f32 v211, v211
    v_cvt_pk_bf16_f32 v112, v208, v209
    v_exp_f32 v212, v212
    v_exp_f32 v213, v213
    v_cvt_pk_bf16_f32 v113, v210, v211
    v_exp_f32 v214, v214
    v_exp_f32 v215, v215
    v_cvt_pk_bf16_f32 v114, v212, v213
    v_exp_f32 v216, v216
    v_exp_f32 v217, v217
    v_cvt_pk_bf16_f32 v115, v214, v215
    v_exp_f32 v218, v218
    v_exp_f32 v219, v219
    v_cvt_pk_bf16_f32 v116, v216, v217
    v_exp_f32 v220, v220
    v_exp_f32 v221, v221
    v_cvt_pk_bf16_f32 v117, v218, v219
    v_exp_f32 v222, v222
    v_exp_f32 v223, v223
    v_cvt_pk_bf16_f32 v118, v220, v221
    v_cvt_pk_bf16_f32 v119, v222, v223
    v_mfma_f32_32x32x16_bf16 v[80:95], v[144:147], v[112:115], v[80:95]
    s_nop 0
    v_mfma_f32_32x32x16_bf16 v[80:95], v[184:187], v[116:119], v[80:95]
    s_cmp_eq_u32 s62, 2
    s_cbranch_scc1 Lc_14o
Lc_14:
    v_mfma_f32_32x32x16_bf16 v[208:223], a[84:87], a[64:67], v[64:79]
    s_nop 11
    v_exp_f32 v208, v208
    v_exp_f32 v209, v209
    v_exp_f32 v210, v210
    v_exp_f32 v211, v211
    v_cvt_pk_bf16_f32 v112, v208, v209
    v_exp_f32 v212, v212
    v_exp_f32 v213, v213
    v_cvt_pk_bf16_f32 v113, v210, v211
    v_exp_f32 v214, v214
    v_exp_f32 v215, v215
    v_cvt_pk_bf16_f32 v114, v212, v213
    v_exp_f32 v216, v216
    v_exp_f32 v217, v217
    v_cvt_pk_bf16_f32 v115, v214, v215
    v_exp_f32 v218, v218
    v_exp_f32 v219, v219
    v_cvt_pk_bf16_f32 v116, v216, v217
    v_exp_f32 v220, v220
    v_exp_f32 v221, v221
    v_cvt_pk_bf16_f32 v117, v218, v219
    v_exp_f32 v222, v222
    v_exp_f32 v223, v223
    v_cvt_pk_bf16_f32 v118, v220, v221
    v_cvt_pk_bf16_f32 v119, v222, v223
    v_mfma_f32_32x32x16_bf16 v[80:95], v[140:143], v[112:115], v[80:95]
    s_nop 0
    v_mfma_f32_32x32x16_bf16 v[80:95], v[180:183], v[116:119], v[80:95]
    v_mfma_f32_32x32x16_bf16 v[208:223], a[80:83], a[64:67], v[64:79]
    s_nop 11
    v_exp_f32 v208, v208
    v_exp_f32 v209, v209
    v_exp_f32 v210, v210
    v_exp_f32 v211, v211
    v_cvt_pk_bf16_f32 v112, v208, v209
    v_exp_f32 v212, v212
    v_exp_f32 v213, v213
    v_cvt_pk_bf16_f32 v113, v210, v211
    v_exp_f32 v214, v214
    v_exp_f32 v215, v215
    v_cvt_pk_bf16_f32 v114, v212, v213
    v_exp_f32 v216, v216
    v_exp_f32 v217, v217
    v_cvt_pk_bf16_f32 v115, v214, v215
    v_exp_f32 v218, v218
    v_exp_f32 v219, v219
    v_cvt_pk_bf16_f32 v116, v216, v217
    v_exp_f32 v220, v220
    v_exp_f32 v221, v221
    v_cvt_pk_bf16_f32 v117, v218, v219
    v_exp_f32 v222, v222
    v_exp_f32 v223, v223
    v_cvt_pk_bf16_f32 v118, v220, v221
    v_cvt_pk_bf16_f32 v119, v222, v223
    v_mfma_f32_32x32x16_bf16 v[80:95], v[136:139], v[112:115], v[80:95]
    s_nop 0
    v_mfma_f32_32x32x16_bf16 v[80:95], v[176:179], v[116:119], v[80:95]
    s_cmp_eq_u32 s62, 3
    s_cbranch_scc1 Lc_15o
Lc_15:
    v_mfma_f32_32x32x16_bf16 v[208:223], a[76:79], a[64:67], v[64:79]
    s_nop 11
    v_exp_f32 v208, v208
    v_exp_f32 v209, v209
    v_exp_f32 v210, v210
    v_exp_f32 v211, v211
    v_cvt_pk_bf16_f32 v112, v208, v209
    v_exp_f32 v212, v212
    v_exp_f32 v213, v213
    v_cvt_pk_bf16_f32 v113, v210, v211
    v_exp_f32 v214, v214
    v_exp_f32 v215, v215
    v_cvt_pk_bf16_f32 v114, v212, v213
    v_exp_f32 v216, v216
    v_exp_f32 v217, v217
    v_cvt_pk_bf16_f32 v115, v214, v215
    v_exp_f32 v218, v218
    v_exp_f32 v219, v219
    v_cvt_pk_bf16_f32 v116, v216, v217
    v_exp_f32 v220, v220
    v_exp_f32 v221, v221
    v_cvt_pk_bf16_f32 v117, v218, v219
    v_exp_f32 v222, v222
    v_exp_f32 v223, v223
    v_cvt_pk_bf16_f32 v118, v220, v221
    v_cvt_pk_bf16_f32 v119, v222, v223
    v_mfma_f32_32x32x16_bf16 v[80:95], v[132:135], v[112:115], v[80:95]
    s_nop 0
    v_mfma_f32_32x32x16_bf16 v[80:95], v[172:175], v[116:119], v[80:95]
    v_mfma_f32_32x32x16_bf16 v[208:223], a[76:79], a[68:71], 0
    v_mfma_f32_32x32x16_bf16 v[224:239], a[108:111], a[68:71], 0
    s_nop 11
    v_cndmask_b32 v224, v208, v224, s[68:69]
    v_cndmask_b32 v225, v209, v225, s[70:71]
    v_cndmask_b32 v226, v210, v226, s[72:73]
    v_cndmask_b32 v227, v211, v227, s[74:75]
    v_cndmask_b32 v228, v212, v228, s[76:77]
    v_cndmask_b32 v229, v213, v229, s[78:79]
    v_cndmask_b32 v230, v214, v230, s[80:81]
    v_cndmask_b32 v231, v215, v231, s[82:83]
    v_cndmask_b32 v232, v216, v232, s[84:85]
    v_cndmask_b32 v233, v217, v233, s[86:87]
    v_cndmask_b32 v234, v218, v234, s[88:89]
    v_cndmask_b32 v235, v219, v235, s[90:91]
    v_cndmask_b32 v236, v220, v236, s[92:93]
    v_cndmask_b32 v237, v221, v237, s[94:95]
    v_cndmask_b32 v238, v222, v238, s[96:97]
    v_cndmask_b32 v239, v223, v239, s[98:99]
    s_nop 15
    s_branch Lx_7
Lx_16o:
    s_cmp_lt_u32 s62, 4
    s_cbranch_scc1 Lx_16e
    s_waitcnt vmcnt(0) lgkmcnt(0)
    s_nop 15
    v_mfma_f32_32x32x16_bf16 v[208:223], a[76:79], a[68:71], 0
    v_mfma_f32_32x32x16_bf16 v[224:239], a[108:111], a[68:71], 0
    s_nop 11
    v_cndmask_b32 v96, v208, v224, s[68:69]
    v_cndmask_b32 v97, v209, v225, s[70:71]
    v_cndmask_b32 v98, v210, v226, s[72:73]
    v_cndmask_b32 v99, v211, v227, s[74:75]
    v_cndmask_b32 v100, v212, v228, s[76:77]
    v_cndmask_b32 v101, v213, v229, s[78:79]
    v_cndmask_b32 v102, v214, v230, s[80:81]
    v_cndmask_b32 v103, v215, v231, s[82:83]
    v_cndmask_b32 v104, v216, v232, s[84:85]
    v_cndmask_b32 v105, v217, v233, s[86:87]
    v_cndmask_b32 v106, v218, v234, s[88:89]
    v_cndmask_b32 v107, v219, v235, s[90:91]
    v_cndmask_b32 v108, v220, v236, s[92:93]
    v_cndmask_b32 v109, v221, v237, s[94:95]
    v_cndmask_b32 v110, v222, v238, s[96:97]
    v_cndmask_b32 v111, v223, v239, s[98:99]
    v_max_f32 v2, v96, v97
    v_max3_f32 v2, v2, v98, v99
    v_max3_f32 v2, v2, v100, v101
    v_max3_f32 v2, v2, v102, v103
    v_max3_f32 v2, v2, v104, v105
    v_max3_f32 v2, v2, v106, v107
    v_max3_f32 v2, v2, v108, v109
    v_max3_f32 v2, v2, v110, v111
    v_mfma_f32_32x32x16_bf16 v[208:223], a[104:107], a[68:71], 0
    s_nop 11
    v_max3_f32 v2, v2, v208, v209
    v_max3_f32 v2, v2, v210, v211
    v_max3_f32 v2, v2, v212, v213
    v_max3_f32 v2, v2, v214, v215
    v_max3_f32 v2, v2, v216, v217
    v_max3_f32 v2, v2, v218, v219
    v_max3_f32 v2, v2, v220, v221
    v_max3_f32 v2, v2, v222, v223
    v_mfma_f32_32x32x16_bf16 v[208:223], a[100:103], a[68:71], 0
    s_nop 11
    v_max3_f32 v2, v2, v208, v209
    v_max3_f32 v2, v2, v210, v211
    v_max3_f32 v2, v2, v212, v213
    v_max3_f32 v2, v2, v214, v215
    v_max3_f32 v2, v2, v216, v217
    v_max3_f32 v2, v2, v218, v219
    v_max3_f32 v2, v2, v220, v221
    v_max3_f32 v2, v2, v222, v223
    v_mfma_f32_32x32x16_bf16 v[208:223], a[96:99], a[68:71], 0
    s_nop 11
    v_max3_f32 v2, v2, v208, v209
    v_max3_f32 v2, v2, v210, v211
    v_max3_f32 v2, v2, v212, v213
    v_max3_f32 v2, v2, v214, v215
    v_max3_f32 v2, v2, v216, v217
    v_max3_f32 v2, v2, v218, v219
    v_max3_f32 v2, v2, v220, v221
    v_max3_f32 v2, v2, v222, v223
    v_mfma_f32_32x32x16_bf16 v[208:223], a[92:95], a[68:71], 0
    s_nop 11
    v_max3_f32 v2, v2, v208, v209
    v_max3_f32 v2, v2, v210, v211
    v_max3_f32 v2, v2, v212, v213
    v_max3_f32 v2, v2, v214, v215
    v_max3_f32 v2, v2, v216, v217
    v_max3_f32 v2, v2, v218, v219
    v_max3_f32 v2, v2, v220, v221
    v_max3_f32 v2, v2, v222, v223
    v_mfma_f32_32x32x16_bf16 v[208:223], a[88:91], a[68:71], 0
    s_nop 11
    v_max3_f32 v2, v2, v208, v209
    v_max3_f32 v2, v2, v210, v211
    v_max3_f32 v2, v2, v212, v213
    v_max3_f32 v2, v2, v214, v215
    v_max3_f32 v2, v2, v216, v217
    v_max3_f32 v2, v2, v218, v219
    v_max3_f32 v2, v2, v220, v221
    v_max3_f32 v2, v2, v222, v223
    v_mfma_f32_32x32x16_bf16 v[208:223], a[84:87], a[68:71], 0
    s_nop 11
    v_max3_f32 v2, v2, v208, v209
    v_max3_f32 v2, v2, v210, v211
    v_max3_f32 v2, v2, v212, v213
    v_max3_f32 v2, v2, v214, v215
    v_max3_f32 v2, v2, v216, v217
    v_max3_f32 v2, v2, v218, v219
    v_max3_f32 v2, v2, v220, v221
    v_max3_f32 v2, v2, v222, v223
    v_mfma_f32_32x32x16_bf16 v[208:223], a[80:83], a[68:71], 0
    s_nop 11
    v_max3_f32 v2, v2, v208, v209
    v_max3_f32 v2, v2, v210, v211
    v_max3_f32 v2, v2, v212, v213
    v_max3_f32 v2, v2, v214, v215
    v_max3_f32 v2, v2, v216, v217
    v_max3_f32 v2, v2, v218, v219
    v_max3_f32 v2, v2, v220, v221
    v_max3_f32 v2, v2, v222, v223
    v_mov_b32 v3, v2
    s_nop 1
    v_permlane32_swap_b32 v2, v3
    v_max_f32 v2, v2, v3
    v_sub_f32 v64, 0, v2
    v_sub_f32 v65, 0, v2
    v_sub_f32 v66, 0, v2
    v_sub_f32 v67, 0, v2
    v_sub_f32 v68, 0, v2
    v_sub_f32 v69, 0, v2
    v_sub_f32 v70, 0, v2
    v_sub_f32 v71, 0, v2
    v_sub_f32 v72, 0, v2
    v_sub_f32 v73, 0, v2
    v_sub_f32 v74, 0, v2
    v_sub_f32 v75, 0, v2
    v_sub_f32 v76, 0, v2
    v_sub_f32 v77, 0, v2
    v_sub_f32 v78, 0, v2
    v_sub_f32 v79, 0, v2
    v_sub_f32 v96, v96, v2
    v_sub_f32 v97, v97, v2
    v_sub_f32 v98, v98, v2
    v_sub_f32 v99, v99, v2
    v_sub_f32 v100, v100, v2
    v_sub_f32 v101, v101, v2
    v_sub_f32 v102, v102, v2
    v_sub_f32 v103, v103, v2
    v_sub_f32 v104, v104, v2
    v_sub_f32 v105, v105, v2
    v_sub_f32 v106, v106, v2
    v_sub_f32 v107, v107, v2
    v_sub_f32 v108, v108, v2
    v_sub_f32 v109, v109, v2
    v_sub_f32 v110, v110, v2
    v_sub_f32 v111, v111, v2
    v_exp_f32 v96, v96
    v_exp_f32 v97, v97
    v_exp_f32 v98, v98
    v_exp_f32 v99, v99
    v_cvt_pk_bf16_f32 v112, v96, v97
    v_exp_f32 v100, v100
    v_exp_f32 v101, v101
    v_cvt_pk_bf16_f32 v113, v98, v99
    v_exp_f32 v102, v102
    v_exp_f32 v103, v103
    v_cvt_pk_bf16_f32 v114, v100, v101
    v_exp_f32 v104, v104
    v_exp_f32 v105, v105
    v_cvt_pk_bf16_f32 v115, v102, v103
    v_exp_f32 v106, v106
    v_exp_f32 v107, v107
    v_cvt_pk_bf16_f32 v116, v104, v105
    v_exp_f32 v108, v108
    v_exp_f32 v109, v109
    v_cvt_pk_bf16_f32 v117, v106, v107
    v_exp_f32 v110, v110
    v_exp_f32 v111, v111
    v_cvt_pk_bf16_f32 v118, v108, v109
    v_cvt_pk_bf16_f32 v119, v110, v111
    v_bfi_b32 v48, v56, 0, v112
    v_and_b32 v112, v56, v112
    v_bfi_b32 v49, v57, 0, v113
    v_and_b32 v113, v57, v113
    v_bfi_b32 v50, v58, 0, v114
    v_and_b32 v114, v58, v114
    v_bfi_b32 v51, v59, 0, v115
    v_and_b32 v115, v59, v115
    v_bfi_b32 v52, v60, 0, v116
    v_and_b32 v116, v60, v116
    v_bfi_b32 v53, v61, 0, v117
    v_and_b32 v117, v61, v117
    v_bfi_b32 v54, v62, 0, v118
    v_and_b32 v118, v62, v118
    v_bfi_b32 v55, v63, 0, v119
    v_and_b32 v119, v63, v119
    v_mfma_f32_32x32x16_bf16 v[80:95], v[164:167], v[112:115], 0
    s_nop 0
    v_mfma_f32_32x32x16_bf16 v[80:95], v[204:207], v[116:119], v[80:95]
    v_mfma_f32_32x32x16_bf16 v[80:95], v[132:135], v[48:51], v[80:95]
    v_mfma_f32_32x32x16_bf16 v[80:95], v[172:175], v[52:55], v[80:95]
    v_mfma_f32_32x32x16_bf16 v[208:223], a[104:107], a[68:71], v[64:79]
    s_nop 11
    v_exp_f32 v208, v208
    v_exp_f32 v209, v209
    v_exp_f32 v210, v210
    v_exp_f32 v211, v211
    v_cvt_pk_bf16_f32 v112, v208, v209
    v_exp_f32 v212, v212
    v_exp_f32 v213, v213
    v_cvt_pk_bf16_f32 v113, v210, v211
    v_exp_f32 v214, v214
    v_exp_f32 v215, v215
    v_cvt_pk_bf16_f32 v114, v212, v213
    v_exp_f32 v216, v216
    v_exp_f32 v217, v217
    v_cvt_pk_bf16_f32 v115, v214, v215
    v_exp_f32 v218, v218
    v_exp_f32 v219, v219
    v_cvt_pk_bf16_f32 v116, v216, v217
    v_exp_f32 v220, v220
    v_exp_f32 v221, v221
    v_cvt_pk_bf16_f32 v117, v218, v219
    v_exp_f32 v222, v222
    v_exp_f32 v223, v223
    v_cvt_pk_bf16_f32 v118, v220, v221
    v_cvt_pk_bf16_f32 v119, v222, v223
    v_mfma_f32_32x32x16_bf16 v[80:95], v[160:163], v[112:115], v[80:95]
    s_nop 0
    v_mfma_f32_32x32x16_bf16 v[80:95], v[200:203], v[116:119], v[80:95]
    v_mfma_f32_32x32x16_bf16 v[208:223], a[100:103], a[68:71], v[64:79]
    s_nop 11
    v_exp_f32 v208, v208
    v_exp_f32 v209, v209
    v_exp_f32 v210, v210
    v_exp_f32 v211, v211
    v_cvt_pk_bf16_f32 v112, v208, v209
    v_exp_f32 v212, v212
    v_exp_f32 v213, v213
    v_cvt_pk_bf16_f32 v113, v210, v211
    v_exp_f32 v214, v214
    v_exp_f32 v215, v215
    v_cvt_pk_bf16_f32 v114, v212, v213
    v_exp_f32 v216, v216
    v_exp_f32 v217, v217
    v_cvt_pk_bf16_f32 v115, v214, v215
    v_exp_f32 v218, v218
    v_exp_f32 v219, v219
    v_cvt_pk_bf16_f32 v116, v216, v217
    v_exp_f32 v220, v220
    v_exp_f32 v221, v221
    v_cvt_pk_bf16_f32 v117, v218, v219
    v_exp_f32 v222, v222
    v_exp_f32 v223, v223
    v_cvt_pk_bf16_f32 v118, v220, v221
    v_cvt_pk_bf16_f32 v119, v222, v223
    v_mfma_f32_32x32x16_bf16 v[80:95], v[156:159], v[112:115], v[80:95]
    s_nop 0
    v_mfma_f32_32x32x16_bf16 v[80:95], v[196:199], v[116:119], v[80:95]
    v_mfma_f32_32x32x16_bf16 v[208:223], a[96:99], a[68:71], v[64:79]
    s_nop 11
    v_exp_f32 v208, v208
    v_exp_f32 v209, v209
    v_exp_f32 v210, v210
    v_exp_f32 v211, v211
    v_cvt_pk_bf16_f32 v112, v208, v209
    v_exp_f32 v212, v212
    v_exp_f32 v213, v213
    v_cvt_pk_bf16_f32 v113, v210, v211
    v_exp_f32 v214, v214
    v_exp_f32 v215, v215
    v_cvt_pk_bf16_f32 v114, v212, v213
    v_exp_f32 v216, v216
    v_exp_f32 v217, v217
    v_cvt_pk_bf16_f32 v115, v214, v215
    v_exp_f32 v218, v218
    v_exp_f32 v219, v219
    v_cvt_pk_bf16_f32 v116, v216, v217
    v_exp_f32 v220, v220
    v_exp_f32 v221, v221
    v_cvt_pk_bf16_f32 v117, v218, v219
    v_exp_f32 v222, v222
    v_exp_f32 v223, v223
    v_cvt_pk_bf16_f32 v118, v220, v221
    v_cvt_pk_bf16_f32 v119, v222, v223
    v_mfma_f32_32x32x16_bf16 v[80:95], v[152:155], v[112:115], v[80:95]
    s_nop 0
    v_mfma_f32_32x32x16_bf16 v[80:95], v[192:195], v[116:119], v[80:95]
    v_mfma_f32_32x32x16_bf16 v[208:223], a[92:95], a[68:71], v[64:79]
    s_nop 11
    v_exp_f32 v208, v208
    v_exp_f32 v209, v209
    v_exp_f32 v210, v210
    v_exp_f32 v211, v211
    v_cvt_pk_bf16_f32 v112, v208, v209
    v_exp_f32 v212, v212
    v_exp_f32 v213, v213
    v_cvt_pk_bf16_f32 v113, v210, v211
    v_exp_f32 v214, v214
    v_exp_f32 v215, v215
    v_cvt_pk_bf16_f32 v114, v212, v213
    v_exp_f32 v216, v216
    v_exp_f32 v217, v217
    v_cvt_pk_bf16_f32 v115, v214, v215
    v_exp_f32 v218, v218
    v_exp_f32 v219, v219
    v_cvt_pk_bf16_f32 v116, v216, v217
    v_exp_f32 v220, v220
    v_exp_f32 v221, v221
    v_cvt_pk_bf16_f32 v117, v218, v219
    v_exp_f32 v222, v222
    v_exp_f32 v223, v223
    v_cvt_pk_bf16_f32 v118, v220, v221
    v_cvt_pk_bf16_f32 v119, v222, v223
    v_mfma_f32_32x32x16_bf16 v[80:95], v[148:151], v[112:115], v[80:95]
    s_nop 0
    v_mfma_f32_32x32x16_bf16 v[80:95], v[188:191], v[116:119], v[80:95]
    v_mfma_f32_32x32x16_bf16 v[208:223], a[88:91], a[68:71], v[64:79]
    s_nop 11
    v_exp_f32 v208, v208
    v_exp_f32 v209, v209
    v_exp_f32 v210, v210
    v_exp_f32 v211, v211
    v_cvt_pk_bf16_f32 v112, v208, v209
    v_exp_f32 v212, v212
    v_exp_f32 v213, v213
    v_cvt_pk_bf16_f32 v113, v210, v211
    v_exp_f32 v214, v214
    v_exp_f32 v215, v215
    v_cvt_pk_bf16_f32 v114, v212, v213
    v_exp_f32 v216, v216
    v_exp_f32 v217, v217
    v_cvt_pk_bf16_f32 v115, v214, v215
    v_exp_f32 v218, v218
    v_exp_f32 v219, v219
    v_cvt_pk_bf16_f32 v116, v216, v217
    v_exp_f32 v220, v220
    v_exp_f32 v221, v221
    v_cvt_pk_bf16_f32 v117, v218, v219
    v_exp_f32 v222, v222
    v_exp_f32 v223, v223
    v_cvt_pk_bf16_f32 v118, v220, v221
    v_cvt_pk_bf16_f32 v119, v222, v223
    v_mfma_f32_32x32x16_bf16 v[80:95], v[144:147], v[112:115], v[80:95]
    s_nop 0
    v_mfma_f32_32x32x16_bf16 v[80:95], v[184:187], v[116:119], v[80:95]
    v_mfma_f32_32x32x16_bf16 v[208:223], a[84:87], a[68:71], v[64:79]
    s_nop 11
    v_exp_f32 v208, v208
    v_exp_f32 v209, v209
    v_exp_f32 v210, v210
    v_exp_f32 v211, v211
    v_cvt_pk_bf16_f32 v112, v208, v209
    v_exp_f32 v212, v212
    v_exp_f32 v213, v213
    v_cvt_pk_bf16_f32 v113, v210, v211
    v_exp_f32 v214, v214
    v_exp_f32 v215, v215
    v_cvt_pk_bf16_f32 v114, v212, v213
    v_exp_f32 v216, v216
    v_exp_f32 v217, v217
    v_cvt_pk_bf16_f32 v115, v214, v215
    v_exp_f32 v218, v218
    v_exp_f32 v219, v219
    v_cvt_pk_bf16_f32 v116, v216, v217
    v_exp_f32 v220, v220
    v_exp_f32 v221, v221
    v_cvt_pk_bf16_f32 v117, v218, v219
    v_exp_f32 v222, v222
    v_exp_f32 v223, v223
    v_cvt_pk_bf16_f32 v118, v220, v221
    v_cvt_pk_bf16_f32 v119, v222, v223
    v_mfma_f32_32x32x16_bf16 v[80:95], v[140:143], v[112:115], v[80:95]
    s_nop 0
    v_mfma_f32_32x32x16_bf16 v[80:95], v[180:183], v[116:119], v[80:95]
    v_mfma_f32_32x32x16_bf16 v[208:223], a[80:83], a[68:71], v[64:79]
    s_nop 11
    v_exp_f32 v208, v208
    v_exp_f32 v209, v209
    v_exp_f32 v210, v210
    v_exp_f32 v211, v211
    v_cvt_pk_bf16_f32 v112, v208, v209
    v_exp_f32 v212, v212
    v_exp_f32 v213, v213
    v_cvt_pk_bf16_f32 v113, v210, v211
    v_exp_f32 v214, v214
    v_exp_f32 v215, v215
    v_cvt_pk_bf16_f32 v114, v212, v213
    v_exp_f32 v216, v216
    v_exp_f32 v217, v217
    v_cvt_pk_bf16_f32 v115, v214, v215
    v_exp_f32 v218, v218
    v_exp_f32 v219, v219
    v_cvt_pk_bf16_f32 v116, v216, v217
    v_exp_f32 v220, v220
    v_exp_f32 v221, v221
    v_cvt_pk_bf16_f32 v117, v218, v219
    v_exp_f32 v222, v222
    v_exp_f32 v223, v223
    v_cvt_pk_bf16_f32 v118, v220, v221
    v_cvt_pk_bf16_f32 v119, v222, v223
    v_mfma_f32_32x32x16_bf16 v[80:95], v[136:139], v[112:115], v[80:95]
    s_nop 0
    v_mfma_f32_32x32x16_bf16 v[80:95], v[176:179], v[116:119], v[80:95]
    s_nop 15
    s_branch Lx_16
Lx_16e:
    s_waitcnt vmcnt(0) lgkmcnt(0)
    s_nop 15
    v_mov_b64 v[64:65], 0
    v_mov_b64 v[66:67], 0
    v_mov_b64 v[68:69], 0
    v_mov_b64 v[70:71], 0
    v_mov_b64 v[72:73], 0
    v_mov_b64 v[74:75], 0
    v_mov_b64 v[76:77], 0
    v_mov_b64 v[78:79], 0
    v_mfma_f32_32x32x16_bf16 v[224:239], a[108:111], a[68:71], 0
    s_nop 11
    v_cndmask_b32 v96, v4, v224, s[68:69]
    v_cndmask_b32 v97, v4, v225, s[70:71]
    v_cndmask_b32 v98, v4, v226, s[72:73]
    v_cndmask_b32 v99, v4, v227, s[74:75]
    v_cndmask_b32 v100, v4, v228, s[76:77]
    v_cndmask_b32 v101, v4, v229, s[78:79]
    v_cndmask_b32 v102, v4, v230, s[80:81]
    v_cndmask_b32 v103, v4, v231, s[82:83]
    v_cndmask_b32 v104, v4, v232, s[84:85]
    v_cndmask_b32 v105, v4, v233, s[86:87]
    v_cndmask_b32 v106, v4, v234, s[88:89]
    v_cndmask_b32 v107, v4, v235, s[90:91]
    v_cndmask_b32 v108, v4, v236, s[92:93]
    v_cndmask_b32 v109, v4, v237, s[94:95]
    v_cndmask_b32 v110, v4, v238, s[96:97]
    v_cndmask_b32 v111, v4, v239, s[98:99]
    v_max_f32 v2, v96, v97
    v_max3_f32 v2, v2, v98, v99
    v_max3_f32 v2, v2, v100, v101
    v_max3_f32 v2, v2, v102, v103
    v_max3_f32 v2, v2, v104, v105
    v_max3_f32 v2, v2, v106, v107
    v_max3_f32 v2, v2, v108, v109
    v_max3_f32 v2, v2, v110, v111
    v_mfma_f32_32x32x16_bf16 v[208:223], a[104:107], a[68:71], v[64:79]
    s_nop 11
    v_max3_f32 v2, v2, v208, v209
    v_max3_f32 v2, v2, v210, v211
    v_max3_f32 v2, v2, v212, v213
    v_max3_f32 v2, v2, v214, v215
    v_max3_f32 v2, v2, v216, v217
    v_max3_f32 v2, v2, v218, v219
    v_max3_f32 v2, v2, v220, v221
    v_max3_f32 v2, v2, v222, v223
    s_cmp_eq_u32 s62, 0
    s_cbranch_scc1 Lc_17o
Lc_17:
    v_mfma_f32_32x32x16_bf16 v[208:223], a[100:103], a[68:71], v[64:79]
    s_nop 11
    v_max3_f32 v2, v2, v208, v209
    v_max3_f32 v2, v2, v210, v211
    v_max3_f32 v2, v2, v212, v213
    v_max3_f32 v2, v2, v214, v215
    v_max3_f32 v2, v2, v216, v217
    v_max3_f32 v2, v2, v218, v219
    v_max3_f32 v2, v2, v220, v221
    v_max3_f32 v2, v2, v222, v223
    v_mfma_f32_32x32x16_bf16 v[208:223], a[96:99], a[68:71], v[64:79]
    s_nop 11
    v_max3_f32 v2, v2, v208, v209
    v_max3_f32 v2, v2, v210, v211
    v_max3_f32 v2, v2, v212, v213
    v_max3_f32 v2, v2, v214, v215
    v_max3_f32 v2, v2, v216, v217
    v_max3_f32 v2, v2, v218, v219
    v_max3_f32 v2, v2, v220, v221
    v_max3_f32 v2, v2, v222, v223
    s_cmp_eq_u32 s62, 1
    s_cbranch_scc1 Lc_18o
Lc_18:
    v_mfma_f32_32x32x16_bf16 v[208:223], a[92:95], a[68:71], v[64:79]
    s_nop 11
    v_max3_f32 v2, v2, v208, v209
    v_max3_f32 v2, v2, v210, v211
    v_max3_f32 v2, v2, v212, v213
    v_max3_f32 v2, v2, v214, v215
    v_max3_f32 v2, v2, v216, v217
    v_max3_f32 v2, v2, v218, v219
    v_max3_f32 v2, v2, v220, v221
    v_max3_f32 v2, v2, v222, v223
    v_mfma_f32_32x32x16_bf16 v[208:223], a[88:91], a[68:71], v[64:79]
    s_nop 11
    v_max3_f32 v2, v2, v208, v209
    v_max3_f32 v2, v2, v210, v211
    v_max3_f32 v2, v2, v212, v213
    v_max3_f32 v2, v2, v214, v215
    v_max3_f32 v2, v2, v216, v217
    v_max3_f32 v2, v2, v218, v219
    v_max3_f32 v2, v2, v220, v221
    v_max3_f32 v2, v2, v222, v223
    s_cmp_eq_u32 s62, 2
    s_cbranch_scc1 Lc_19o
Lc_19:
    v_mfma_f32_32x32x16_bf16 v[208:223], a[84:87], a[68:71], v[64:79]
    s_nop 11
    v_max3_f32 v2, v2, v208, v209
    v_max3_f32 v2, v2, v210, v211
    v_max3_f32 v2, v2, v212, v213
    v_max3_f32 v2, v2, v214, v215
    v_max3_f32 v2, v2, v216, v217
    v_max3_f32 v2, v2, v218, v219
    v_max3_f32 v2, v2, v220, v221
    v_max3_f32 v2, v2, v222, v223
    v_mfma_f32_32x32x16_bf16 v[208:223], a[80:83], a[68:71], v[64:79]
    s_nop 11
    v_max3_f32 v2, v2, v208, v209
    v_max3_f32 v2, v2, v210, v211
    v_max3_f32 v2, v2, v212, v213
    v_max3_f32 v2, v2, v214, v215
    v_max3_f32 v2, v2, v216, v217
    v_max3_f32 v2, v2, v218, v219
    v_max3_f32 v2, v2, v220, v221
    v_max3_f32 v2, v2, v222, v223
    v_mov_b32 v3, v2
    s_nop 1
    v_permlane32_swap_b32 v2, v3
    v_max_f32 v2, v2, v3
    v_sub_f32 v64, 0, v2
    v_sub_f32 v65, 0, v2
    v_sub_f32 v66, 0, v2
    v_sub_f32 v67, 0, v2
    v_sub_f32 v68, 0, v2
    v_sub_f32 v69, 0, v2
    v_sub_f32 v70, 0, v2
    v_sub_f32 v71, 0, v2
    v_sub_f32 v72, 0, v2
    v_sub_f32 v73, 0, v2
    v_sub_f32 v74, 0, v2
    v_sub_f32 v75, 0, v2
    v_sub_f32 v76, 0, v2
    v_sub_f32 v77, 0, v2
    v_sub_f32 v78, 0, v2
    v_sub_f32 v79, 0, v2
    v_sub_f32 v96, v96, v2
    v_sub_f32 v97, v97, v2
    v_sub_f32 v98, v98, v2
    v_sub_f32 v99, v99, v2
    v_sub_f32 v100, v100, v2
    v_sub_f32 v101, v101, v2
    v_sub_f32 v102, v102, v2
    v_sub_f32 v103, v103, v2
    v_sub_f32 v104, v104, v2
    v_sub_f32 v105, v105, v2
    v_sub_f32 v106, v106, v2
    v_sub_f32 v107, v107, v2
    v_sub_f32 v108, v108, v2
    v_sub_f32 v109, v109, v2
    v_sub_f32 v110, v110, v2
    v_sub_f32 v111, v111, v2
    v_exp_f32 v96, v96
    v_exp_f32 v97, v97
    v_exp_f32 v98, v98
    v_exp_f32 v99, v99
    v_cvt_pk_bf16_f32 v112, v96, v97
    v_exp_f32 v100, v100
    v_exp_f32 v101, v101
    v_cvt_pk_bf16_f32 v113, v98, v99
    v_exp_f32 v102, v102
    v_exp_f32 v103, v103
    v_cvt_pk_bf16_f32 v114, v100, v101
    v_exp_f32 v104, v104
    v_exp_f32 v105, v105
    v_cvt_pk_bf16_f32 v115, v102, v103
    v_exp_f32 v106, v106
    v_exp_f32 v107, v107
    v_cvt_pk_bf16_f32 v116, v104, v105
    v_exp_f32 v108, v108
    v_exp_f32 v109, v109
    v_cvt_pk_bf16_f32 v117, v106, v107
    v_exp_f32 v110, v110
    v_exp_f32 v111, v111
    v_cvt_pk_bf16_f32 v118, v108, v109
    v_cvt_pk_bf16_f32 v119, v110, v111
    v_mfma_f32_32x32x16_bf16 v[80:95], v[164:167], v[112:115], 0
    s_nop 0
    v_mfma_f32_32x32x16_bf16 v[80:95], v[204:207], v[116:119], v[80:95]
    v_mfma_f32_32x32x16_bf16 v[208:223], a[104:107], a[68:71], v[64:79]
    s_nop 11
    v_exp_f32 v208, v208
    v_exp_f32 v209, v209
    v_exp_f32 v210, v210
    v_exp_f32 v211, v211
    v_cvt_pk_bf16_f32 v112, v208, v209
    v_exp_f32 v212, v212
    v_exp_f32 v213, v213
    v_cvt_pk_bf16_f32 v113, v210, v211
    v_exp_f32 v214, v214
    v_exp_f32 v215, v215
    v_cvt_pk_bf16_f32 v114, v212, v213
    v_exp_f32 v216, v216
    v_exp_f32 v217, v217
    v_cvt_pk_bf16_f32 v115, v214, v215
    v_exp_f32 v218, v218
    v_exp_f32 v219, v219
    v_cvt_pk_bf16_f32 v116, v216, v217
    v_exp_f32 v220, v220
    v_exp_f32 v221, v221
    v_cvt_pk_bf16_f32 v117, v218, v219
    v_exp_f32 v222, v222
    v_exp_f32 v223, v223
    v_cvt_pk_bf16_f32 v118, v220, v221
    v_cvt_pk_bf16_f32 v119, v222, v223
    v_mfma_f32_32x32x16_bf16 v[80:95], v[160:163], v[112:115], v[80:95]
    s_nop 0
    v_mfma_f32_32x32x16_bf16 v[80:95], v[200:203], v[116:119], v[80:95]
    s_cmp_eq_u32 s62, 0
    s_cbranch_scc1 Lc_20o
Lc_20:
    v_mfma_f32_32x32x16_bf16 v[208:223], a[100:103], a[68:71], v[64:79]
    s_nop 11
    v_exp_f32 v208, v208
    v_exp_f32 v209, v209
    v_exp_f32 v210, v210
    v_exp_f32 v211, v211
    v_cvt_pk_bf16_f32 v112, v208, v209
    v_exp_f32 v212, v212
    v_exp_f32 v213, v213
    v_cvt_pk_bf16_f32 v113, v210, v211
    v_exp_f32 v214, v214
    v_exp_f32 v215, v215
    v_cvt_pk_bf16_f32 v114, v212, v213
    v_exp_f32 v216, v216
    v_exp_f32 v217, v217
    v_cvt_pk_bf16_f32 v115, v214, v215
    v_exp_f32 v218, v218
    v_exp_f32 v219, v219
    v_cvt_pk_bf16_f32 v116, v216, v217
    v_exp_f32 v220, v220
    v_exp_f32 v221, v221
    v_cvt_pk_bf16_f32 v117, v218, v219
    v_exp_f32 v222, v222
    v_exp_f32 v223, v223
    v_cvt_pk_bf16_f32 v118, v220, v221
    v_cvt_pk_bf16_f32 v119, v222, v223
    v_mfma_f32_32x32x16_bf16 v[80:95], v[156:159], v[112:115], v[80:95]
    s_nop 0
    v_mfma_f32_32x32x16_bf16 v[80:95], v[196:199], v[116:119], v[80:95]
    v_mfma_f32_32x32x16_bf16 v[208:223], a[96:99], a[68:71], v[64:79]
    s_nop 11
    v_exp_f32 v208, v208
    v_exp_f32 v209, v209
    v_exp_f32 v210, v210
    v_exp_f32 v211, v211
    v_cvt_pk_bf16_f32 v112, v208, v209
    v_exp_f32 v212, v212
    v_exp_f32 v213, v213
    v_cvt_pk_bf16_f32 v113, v210, v211
    v_exp_f32 v214, v214
    v_exp_f32 v215, v215
    v_cvt_pk_bf16_f32 v114, v212, v213
    v_exp_f32 v216, v216
    v_exp_f32 v217, v217
    v_cvt_pk_bf16_f32 v115, v214, v215
    v_exp_f32 v218, v218
    v_exp_f32 v219, v219
    v_cvt_pk_bf16_f32 v116, v216, v217
    v_exp_f32 v220, v220
    v_exp_f32 v221, v221
    v_cvt_pk_bf16_f32 v117, v218, v219
    v_exp_f32 v222, v222
    v_exp_f32 v223, v223
    v_cvt_pk_bf16_f32 v118, v220, v221
    v_cvt_pk_bf16_f32 v119, v222, v223
    v_mfma_f32_32x32x16_bf16 v[80:95], v[152:155], v[112:115], v[80:95]
    s_nop 0
    v_mfma_f32_32x32x16_bf16 v[80:95], v[192:195], v[116:119], v[80:95]
    s_cmp_eq_u32 s62, 1
    s_cbranch_scc1 Lc_21o
Lc_21:
    v_mfma_f32_32x32x16_bf16 v[208:223], a[92:95], a[68:71], v[64:79]
    s_nop 11
    v_exp_f32 v208, v208
    v_exp_f32 v209, v209
    v_exp_f32 v210, v210
    v_exp_f32 v211, v211
    v_cvt_pk_bf16_f32 v112, v208, v209
    v_exp_f32 v212, v212
    v_exp_f32 v213, v213
    v_cvt_pk_bf16_f32 v113, v210, v211
    v_exp_f32 v214, v214
    v_exp_f32 v215, v215
    v_cvt_pk_bf16_f32 v114, v212, v213
    v_exp_f32 v216, v216
    v_exp_f32 v217, v217
    v_cvt_pk_bf16_f32 v115, v214, v215
    v_exp_f32 v218, v218
    v_exp_f32 v219, v219
    v_cvt_pk_bf16_f32 v116, v216, v217
    v_exp_f32 v220, v220
    v_exp_f32 v221, v221
    v_cvt_pk_bf16_f32 v117, v218, v219
    v_exp_f32 v222, v222
    v_exp_f32 v223, v223
    v_cvt_pk_bf16_f32 v118, v220, v221
    v_cvt_pk_bf16_f32 v119, v222, v223
    v_mfma_f32_32x32x16_bf16 v[80:95], v[148:151], v[112:115], v[80:95]
    s_nop 0
    v_mfma_f32_32x32x16_bf16 v[80:95], v[188:191], v[116:119], v[80:95]
    v_mfma_f32_32x32x16_bf16 v[208:223], a[88:91], a[68:71], v[64:79]
    s_nop 11
    v_exp_f32 v208, v208
    v_exp_f32 v209, v209
    v_exp_f32 v210, v210
    v_exp_f32 v211, v211
    v_cvt_pk_bf16_f32 v112, v208, v209
    v_exp_f32 v212, v212
    v_exp_f32 v213, v213
    v_cvt_pk_bf16_f32 v113, v210, v211
    v_exp_f32 v214, v214
    v_exp_f32 v215, v215
    v_cvt_pk_bf16_f32 v114, v212, v213
    v_exp_f32 v216, v216
    v_exp_f32 v217, v217
    v_cvt_pk_bf16_f32 v115, v214, v215
    v_exp_f32 v218, v218
    v_exp_f32 v219, v219
    v_cvt_pk_bf16_f32 v116, v216, v217
    v_exp_f32 v220, v220
    v_exp_f32 v221, v221
    v_cvt_pk_bf16_f32 v117, v218, v219
    v_exp_f32 v222, v222
    v_exp_f32 v223, v223
    v_cvt_pk_bf16_f32 v118, v220, v221
    v_cvt_pk_bf16_f32 v119, v222, v223
    v_mfma_f32_32x32x16_bf16 v[80:95], v[144:147], v[112:115], v[80:95]
    s_nop 0
    v_mfma_f32_32x32x16_bf16 v[80:95], v[184:187], v[116:119], v[80:95]
    s_cmp_eq_u32 s62, 2
    s_cbranch_scc1 Lc_22o
Lc_22:
    v_mfma_f32_32x32x16_bf16 v[208:223], a[84:87], a[68:71], v[64:79]
    s_nop 11
    v_exp_f32 v208, v208
    v_exp_f32 v209, v209
    v_exp_f32 v210, v210
    v_exp_f32 v211, v211
    v_cvt_pk_bf16_f32 v112, v208, v209
    v_exp_f32 v212, v212
    v_exp_f32 v213, v213
    v_cvt_pk_bf16_f32 v113, v210, v211
    v_exp_f32 v214, v214
    v_exp_f32 v215, v215
    v_cvt_pk_bf16_f32 v114, v212, v213
    v_exp_f32 v216, v216
    v_exp_f32 v217, v217
    v_cvt_pk_bf16_f32 v115, v214, v215
    v_exp_f32 v218, v218
    v_exp_f32 v219, v219
    v_cvt_pk_bf16_f32 v116, v216, v217
    v_exp_f32 v220, v220
    v_exp_f32 v221, v221
    v_cvt_pk_bf16_f32 v117, v218, v219
    v_exp_f32 v222, v222
    v_exp_f32 v223, v223
    v_cvt_pk_bf16_f32 v118, v220, v221
    v_cvt_pk_bf16_f32 v119, v222, v223
    v_mfma_f32_32x32x16_bf16 v[80:95], v[140:143], v[112:115], v[80:95]
    s_nop 0
    v_mfma_f32_32x32x16_bf16 v[80:95], v[180:183], v[116:119], v[80:95]
    v_mfma_f32_32x32x16_bf16 v[208:223], a[80:83], a[68:71], v[64:79]
    s_nop 11
    v_exp_f32 v208, v208
    v_exp_f32 v209, v209
    v_exp_f32 v210, v210
    v_exp_f32 v211, v211
    v_cvt_pk_bf16_f32 v112, v208, v209
    v_exp_f32 v212, v212
    v_exp_f32 v213, v213
    v_cvt_pk_bf16_f32 v113, v210, v211
    v_exp_f32 v214, v214
    v_exp_f32 v215, v215
    v_cvt_pk_bf16_f32 v114, v212, v213
    v_exp_f32 v216, v216
    v_exp_f32 v217, v217
    v_cvt_pk_bf16_f32 v115, v214, v215
    v_exp_f32 v218, v218
    v_exp_f32 v219, v219
    v_cvt_pk_bf16_f32 v116, v216, v217
    v_exp_f32 v220, v220
    v_exp_f32 v221, v221
    v_cvt_pk_bf16_f32 v117, v218, v219
    v_exp_f32 v222, v222
    v_exp_f32 v223, v223
    v_cvt_pk_bf16_f32 v118, v220, v221
    v_cvt_pk_bf16_f32 v119, v222, v223
    v_mfma_f32_32x32x16_bf16 v[80:95], v[136:139], v[112:115], v[80:95]
    s_nop 0
    v_mfma_f32_32x32x16_bf16 v[80:95], v[176:179], v[116:119], v[80:95]
    s_nop 15
    s_branch Lx_16
Lc_8o:
    s_nop 7
    v_mov_b32 v64, v4
    v_mov_b32 v65, v4
    v_mov_b32 v66, v4
    v_mov_b32 v67, v4
    v_mov_b32 v68, v4
    v_mov_b32 v69, v4
    v_mov_b32 v70, v4
    v_mov_b32 v71, v4
    v_mov_b32 v72, v4
    v_mov_b32 v73, v4
    v_mov_b32 v74, v4
    v_mov_b32 v75, v4
    v_mov_b32 v76, v4
    v_mov_b32 v77, v4
    v_mov_b32 v78, v4
    v_mov_b32 v79, v4
    s_nop 1
    s_branch Lc_8
Lc_9o:
    s_nop 7
    v_mov_b32 v64, v4
    v_mov_b32 v65, v4
    v_mov_b32 v66, v4
    v_mov_b32 v67, v4
    v_mov_b32 v68, v4
    v_mov_b32 v69, v4
    v_mov_b32 v70, v4
    v_mov_b32 v71, v4
    v_mov_b32 v72, v4
    v_mov_b32 v73, v4
    v_mov_b32 v74, v4
    v_mov_b32 v75, v4
    v_mov_b32 v76, v4
    v_mov_b32 v77, v4
    v_mov_b32 v78, v4
    v_mov_b32 v79, v4
    s_nop 1
    s_branch Lc_9
Lc_10o:
    s_nop 7
    v_mov_b32 v64, v4
    v_mov_b32 v65, v4
    v_mov_b32 v66, v4
    v_mov_b32 v67, v4
    v_mov_b32 v68, v4
    v_mov_b32 v69, v4
    v_mov_b32 v70, v4
    v_mov_b32 v71, v4
    v_mov_b32 v72, v4
    v_mov_b32 v73, v4
    v_mov_b32 v74, v4
    v_mov_b32 v75, v4
    v_mov_b32 v76, v4
    v_mov_b32 v77, v4
    v_mov_b32 v78, v4
    v_mov_b32 v79, v4
    s_nop 1
    s_branch Lc_10
Lc_11o:
    s_nop 7
    v_mov_b32 v64, v4
    v_mov_b32 v65, v4
    v_mov_b32 v66, v4
    v_mov_b32 v67, v4
    v_mov_b32 v68, v4
    v_mov_b32 v69, v4
    v_mov_b32 v70, v4
    v_mov_b32 v71, v4
    v_mov_b32 v72, v4
    v_mov_b32 v73, v4
    v_mov_b32 v74, v4
    v_mov_b32 v75, v4
    v_mov_b32 v76, v4
    v_mov_b32 v77, v4
    v_mov_b32 v78, v4
    v_mov_b32 v79, v4
    s_nop 1
    s_branch Lc_11
Lc_12o:
    s_nop 7
    v_mov_b32 v64, v4
    v_mov_b32 v65, v4
    v_mov_b32 v66, v4
    v_mov_b32 v67, v4
    v_mov_b32 v68, v4
    v_mov_b32 v69, v4
    v_mov_b32 v70, v4
    v_mov_b32 v71, v4
    v_mov_b32 v72, v4
    v_mov_b32 v73, v4
    v_mov_b32 v74, v4
    v_mov_b32 v75, v4
    v_mov_b32 v76, v4
    v_mov_b32 v77, v4
    v_mov_b32 v78, v4
    v_mov_b32 v79, v4
    s_nop 1
    s_branch Lc_12
Lc_13o:
    s_nop 7
    v_mov_b32 v64, v4
    v_mov_b32 v65, v4
    v_mov_b32 v66, v4
    v_mov_b32 v67, v4
    v_mov_b32 v68, v4
    v_mov_b32 v69, v4
    v_mov_b32 v70, v4
    v_mov_b32 v71, v4
    v_mov_b32 v72, v4
    v_mov_b32 v73, v4
    v_mov_b32 v74, v4
    v_mov_b32 v75, v4
    v_mov_b32 v76, v4
    v_mov_b32 v77, v4
    v_mov_b32 v78, v4
    v_mov_b32 v79, v4
    s_nop 1
    s_branch Lc_13
Lc_14o:
    s_nop 7
    v_mov_b32 v64, v4
    v_mov_b32 v65, v4
    v_mov_b32 v66, v4
    v_mov_b32 v67, v4
    v_mov_b32 v68, v4
    v_mov_b32 v69, v4
    v_mov_b32 v70, v4
    v_mov_b32 v71, v4
    v_mov_b32 v72, v4
    v_mov_b32 v73, v4
    v_mov_b32 v74, v4
    v_mov_b32 v75, v4
    v_mov_b32 v76, v4
    v_mov_b32 v77, v4
    v_mov_b32 v78, v4
    v_mov_b32 v79, v4
    s_nop 1
    s_branch Lc_14
Lc_15o:
    s_nop 7
    v_mov_b32 v64, v4
    v_mov_b32 v65, v4
    v_mov_b32 v66, v4
    v_mov_b32 v67, v4
    v_mov_b32 v68, v4
    v_mov_b32 v69, v4
    v_mov_b32 v70, v4
    v_mov_b32 v71, v4
    v_mov_b32 v72, v4
    v_mov_b32 v73, v4
    v_mov_b32 v74, v4
    v_mov_b32 v75, v4
    v_mov_b32 v76, v4
    v_mov_b32 v77, v4
    v_mov_b32 v78, v4
    v_mov_b32 v79, v4
    s_nop 1
    s_branch Lc_15
Lc_17o:
    s_nop 7
    v_mov_b32 v64, v4
    v_mov_b32 v65, v4
    v_mov_b32 v66, v4
    v_mov_b32 v67, v4
    v_mov_b32 v68, v4
    v_mov_b32 v69, v4
    v_mov_b32 v70, v4
    v_mov_b32 v71, v4
    v_mov_b32 v72, v4
    v_mov_b32 v73, v4
    v_mov_b32 v74, v4
    v_mov_b32 v75, v4
    v_mov_b32 v76, v4
    v_mov_b32 v77, v4
    v_mov_b32 v78, v4
    v_mov_b32 v79, v4
    s_nop 1
    s_branch Lc_17
Lc_18o:
    s_nop 7
    v_mov_b32 v64, v4
    v_mov_b32 v65, v4
    v_mov_b32 v66, v4
    v_mov_b32 v67, v4
    v_mov_b32 v68, v4
    v_mov_b32 v69, v4
    v_mov_b32 v70, v4
    v_mov_b32 v71, v4
    v_mov_b32 v72, v4
    v_mov_b32 v73, v4
    v_mov_b32 v74, v4
    v_mov_b32 v75, v4
    v_mov_b32 v76, v4
    v_mov_b32 v77, v4
    v_mov_b32 v78, v4
    v_mov_b32 v79, v4
    s_nop 1
    s_branch Lc_18
Lc_19o:
    s_nop 7
    v_mov_b32 v64, v4
    v_mov_b32 v65, v4
    v_mov_b32 v66, v4
    v_mov_b32 v67, v4
    v_mov_b32 v68, v4
    v_mov_b32 v69, v4
    v_mov_b32 v70, v4
    v_mov_b32 v71, v4
    v_mov_b32 v72, v4
    v_mov_b32 v73, v4
    v_mov_b32 v74, v4
    v_mov_b32 v75, v4
    v_mov_b32 v76, v4
    v_mov_b32 v77, v4
    v_mov_b32 v78, v4
    v_mov_b32 v79, v4
    s_nop 1
    s_branch Lc_19
Lc_20o:
    s_nop 7
    v_mov_b32 v64, v4
    v_mov_b32 v65, v4
    v_mov_b32 v66, v4
    v_mov_b32 v67, v4
    v_mov_b32 v68, v4
    v_mov_b32 v69, v4
    v_mov_b32 v70, v4
    v_mov_b32 v71, v4
    v_mov_b32 v72, v4
    v_mov_b32 v73, v4
    v_mov_b32 v74, v4
    v_mov_b32 v75, v4
    v_mov_b32 v76, v4
    v_mov_b32 v77, v4
    v_mov_b32 v78, v4
    v_mov_b32 v79, v4
    s_nop 1
    s_branch Lc_20
Lc_21o:
    s_nop 7
    v_mov_b32 v64, v4
    v_mov_b32 v65, v4
    v_mov_b32 v66, v4
    v_mov_b32 v67, v4
    v_mov_b32 v68, v4
    v_mov_b32 v69, v4
    v_mov_b32 v70, v4
    v_mov_b32 v71, v4
    v_mov_b32 v72, v4
    v_mov_b32 v73, v4
    v_mov_b32 v74, v4
    v_mov_b32 v75, v4
    v_mov_b32 v76, v4
    v_mov_b32 v77, v4
    v_mov_b32 v78, v4
    v_mov_b32 v79, v4
    s_nop 1
    s_branch Lc_21
Lc_22o:
    s_nop 7
    v_mov_b32 v64, v4
    v_mov_b32 v65, v4
    v_mov_b32 v66, v4
    v_mov_b32 v67, v4
    v_mov_b32 v68, v4
    v_mov_b32 v69, v4
    v_mov_b32 v70, v4
    v_mov_b32 v71, v4
    v_mov_b32 v72, v4
    v_mov_b32 v73, v4
    v_mov_b32 v74, v4
    v_mov_b32 v75, v4
    v_mov_b32 v76, v4
    v_mov_b32 v77, v4
    v_mov_b32 v78, v4
    v_mov_b32 v79, v4
    s_nop 1
    s_branch Lc_22
Lend:
    s_endpgm
.section .rodata,"a"
.p2align 6
.amdhsa_kernel parallel_sum__sliding_block__dense_activation_squared_relu__prompt_kernel
  .amdhsa_next_free_vgpr 512
  .amdhsa_next_free_sgpr 102
  .amdhsa_accum_offset 256
  .amdhsa_group_segment_fixed_size 0
  .amdhsa_kernarg_size 88
  .amdhsa_user_sgpr_count 2
  .amdhsa_user_sgpr_kernarg_segment_ptr 1
  .amdhsa_system_sgpr_workgroup_id_x 1
  .amdhsa_float_denorm_mode_32 3
.end_amdhsa_kernel
```
